```python
import torch

def _softmax(x, axis=-1):
    return torch.softmax(x, dim=axis)
def _gelu(x):
    return torch.nn.functional.gelu(x, approximate="tanh")
def _silu(x):
    return torch.nn.functional.silu(x)
def _sigmoid(x):
    return torch.sigmoid(x)
def _layernorm(x, axis=-1, eps=1e-5):
    m = x.mean(dim=axis, keepdim=True)
    v = x.var(dim=axis, keepdim=True, unbiased=False)
    return (x - m) / torch.sqrt(v + eps)
def _scatter_add(tgt, idx, src, axis=0):
    return tgt.clone().index_add_(axis, idx, src)
def _segment_sum(src, seg, n):
    out = torch.zeros((n,) + src.shape[1:], dtype=src.dtype)
    return out.index_add_(0, seg, src)
def _pad(x, pw):
    flat = tuple(v for pair in reversed(pw) for v in pair)
    return torch.nn.functional.pad(x, flat)

kernel_name = 'sequential_preLN__gqa_block_cached__mixer_token_mlp__decode'

def setup_inputs():

    _w = (lambda a: (lambda t: t.to(torch.bfloat16) if t.is_floating_point() else t)(torch.as_tensor(a)))
    def _A_setup():
        B, Sq, D = 8, 1, 512
        Hq, Hkv, Sk, Dh = 32, 8, 4096, 128
        assert Hq % Hkv == 0, (Hq, Hkv)
        return {
            "x": _w((lambda *s: torch.randn(*s, dtype=torch.bfloat16) * 0.05)(B, Sq, D)),
            "k_cache": _w((lambda *s: torch.randn(*s, dtype=torch.bfloat16) * 1.6)(B, Hkv, Sk, Dh)),
            "v_cache": _w((lambda *s: torch.randn(*s, dtype=torch.bfloat16) * 0.8)(B, Hkv, Sk, Dh)),
            "wq": _w((lambda *s: torch.randn(*s, dtype=torch.bfloat16) * 1.6)(D, Hq * Dh) * (D ** -0.5)),
            "wo": _w((lambda *s: torch.randn(*s, dtype=torch.bfloat16) * 0.8)(Hq * Dh, D) * ((Hq * Dh) ** -0.5)),
        }
    _A_in = _A_setup()

    def _B_setup():
        B, S, D, F = 8, 1, 512, 1792
        return {
            "x": _w((lambda *s: torch.randn(*s, dtype=torch.bfloat16) * 0.05)(B, S, D)),
            "w1": _w((lambda *s: torch.randn(*s, dtype=torch.bfloat16) * 0.8)(S, F) * (S ** -0.5)),
            "b1": _w((lambda *s: torch.randn(*s, dtype=torch.bfloat16) * 0.8)(F) * 0.02),
            "w2": _w((lambda *s: torch.randn(*s, dtype=torch.bfloat16) * 0.8)(F, S) * (F ** -0.5)),
            "b2": _w((lambda *s: torch.randn(*s, dtype=torch.bfloat16) * 0.4)(S) * 0.02),
        }
    _B_in = _B_setup()

    return {
        "A_x": _A_in["x"],
        "A_k_cache": _A_in["k_cache"],
        "A_v_cache": _A_in["v_cache"],
        "A_wq": _A_in["wq"],
        "A_wo": _A_in["wo"],
        "B_x": _B_in["x"],
        "B_w1": _B_in["w1"],
        "B_b1": _B_in["b1"],
        "B_w2": _B_in["w2"],
        "B_b2": _B_in["b2"],
    }

def reference(A_x, A_k_cache, A_v_cache, A_wq, A_wo, B_x, B_w1, B_b1, B_w2, B_b2):
    def _A_ref(x, k_cache, v_cache, wq, wo):
        B, Sq, D = x.shape
        Hq, Dh = 32, 128
        Hkv = k_cache.shape[1]
        rep = Hq // Hkv
        q = (lambda x, *d: x.permute(*d))((x @ wq).reshape(B, Sq, Hq, Dh), 0, 2, 1, 3)
        k = (lambda x, n, axis: torch.repeat_interleave(x, n, dim=axis))(k_cache, rep, axis=1)
        v = (lambda x, n, axis: torch.repeat_interleave(x, n, dim=axis))(v_cache, rep, axis=1)
        scores = torch.einsum("bhqd,bhkd->bhqk", q, k) * (Dh ** -0.5)
        p = _softmax(scores, axis=-1)
        o = torch.einsum("bhqk,bhkd->bhqd", p, v)
        return (lambda x, *d: x.permute(*d))(o, 0, 2, 1, 3).reshape(B, Sq, Hq * Dh) @ wo

    def _B_ref(x, w1, b1, w2, b2):
        B, S, D = x.shape
        h = _layernorm(x, axis=-1)
        u = torch.einsum("bsd,sf->bdf", h, w1) + b1
        u = _gelu(u)
        y = torch.einsum("bdf,fs->bds", u, w2) + b2
        return (lambda x, *d: x.permute(*d))(y, 0, 2, 1)

    x = A_x
    h = x + _A_ref(_layernorm(x, axis=-1), A_k_cache, A_v_cache, A_wq, A_wo)
    h2 = h + _B_ref(_layernorm(h, axis=-1), B_w1, B_b1, B_w2, B_b2)
    return h2
```

```asm
; @launch grid=(256,1,1) block=(512,1,1) lds=163200
.amdgcn_target "amdgcn-amd-amdhsa--gfx950"
.text
.globl sequential_preLN__gqa_block_cached__mixer_token_mlp__decode_kernel
.p2align 8
.type sequential_preLN__gqa_block_cached__mixer_token_mlp__decode_kernel,@function
sequential_preLN__gqa_block_cached__mixer_token_mlp__decode_kernel:
  s_cmp_ge_u32 s2, 256
  s_cbranch_scc1 L_end
  s_load_dwordx16 s[64:79], s[0:1], 0
  s_load_dwordx8 s[80:87], s[0:1], 64
  s_load_dwordx2 s[88:89], s[0:1], 96
  s_memrealtime s[60:61]
  v_lshrrev_b32 v1, 6, v0
  v_and_b32 v0, 63, v0
  v_readfirstlane_b32 s3, v1
  v_and_b32 v12, 15, v0
  v_lshrrev_b32 v13, 4, v0
  s_mov_b32 s4, s2
  s_and_b32 s90, s2, 7
  s_lshr_b32 s91, s2, 5
  s_lshr_b32 s92, s2, 3
  s_and_b32 s92, s92, 3
  s_lshl_b32 s90, s90, 2
  s_or_b32 s90, s90, s92
  s_lshl_b32 s90, s90, 3
  s_or_b32 s2, s90, s91
  s_and_b32 s52, s2, 7
  s_lshr_b32 s53, s2, 3
  s_lshr_b32 s54, s53, 2
  s_and_b32 s55, s53, 3
  v_lshlrev_b32 v1, 4, v0
  s_lshl_b32 s92, s3, 11
  s_cmp_ge_u32 s3, 4
  s_cbranch_scc1 L_stream
  s_setprio 3
  s_and_b32 s62, s54, 4
  s_add_u32 s62, s62, s55
  s_and_b32 s55, s54, 3
  v_mov_b32 v212, -1
  v_mov_b32 v213, -1
  v_mov_b32 v214, -1
  v_mov_b32 v215, -1
  v_lshrrev_b32 v216, 1, v0
  v_and_b32 v217, 1, v0
  v_lshlrev_b32 v217, 4, v217
  v_lshl_add_u32 v218, v216, 13, v217
  s_lshl_b32 s93, s3, 20
  s_lshl_b32 s94, s52, 10
  s_add_u32 s93, s93, s94
  s_lshl_b32 s94, s53, 5
  s_add_u32 s93, s93, s94
  s_lshl_b32 s57, s3, 12
  s_add_u32 s57, s57, 131072
  s_mov_b32 m0, s57
  s_waitcnt lgkmcnt(0)
  s_mov_b32 s28, s64
  s_and_b32 s29, s65, 0xffff
  s_mov_b32 s30, 8192
  s_mov_b32 s31, 0x20000
  buffer_load_dwordx4 v[208:211], v1, s[28:31], s92 offen
  buffer_load_dwordx4 v[232:235], v1, s[28:31], s92 offen offset:1024
  s_mov_b32 s16, s70
  s_and_b32 s17, s71, 0xffff
  s_mov_b32 s18, 4194304
  s_mov_b32 s19, 0x20000
  buffer_load_dwordx4 v218, s[16:19], s93 offen nt lds
  s_add_u32 s94, s57, 1024
  s_mov_b32 m0, s94
  s_add_u32 s93, s93, 262144
  buffer_load_dwordx4 v218, s[16:19], s93 offen nt lds
  s_add_u32 s94, s57, 2048
  s_mov_b32 m0, s94
  s_add_u32 s93, s93, 262144
  buffer_load_dwordx4 v218, s[16:19], s93 offen nt lds
  s_add_u32 s94, s57, 3072
  s_mov_b32 m0, s94
  s_add_u32 s93, s93, 262144
  buffer_load_dwordx4 v218, s[16:19], s93 offen nt lds
  s_mov_b32 s32, s86
  s_and_b32 s33, s87, 0xffff
  s_mov_b32 s34, 256
  s_mov_b32 s35, 0x20000
  s_mov_b32 s24, s88
  s_and_b32 s25, s89, 0xffff
  s_mov_b32 s26, 4194304
  s_mov_b32 s27, 0x20000
  s_cmp_eq_u32 s3, 0
  s_cbranch_scc0 L_w1
  s_or_b32 s60, s60, 1
  v_mov_b32 v220, s60
  v_mov_b32 v221, 0
  s_lshl_b32 s92, s52, 5
  v_mov_b32 v219, s92
  s_mov_b64 exec, 1
  buffer_atomic_cmpswap v[220:221], v219, s[32:35], 0 offen sc0
  buffer_load_dword v226, v219, s[28:31], 0 offen
  s_mov_b64 exec, 0xffff
  v_lshlrev_b32 v222, 2, v0
  v_add_u32 v222, 158912, v222
  v_mov_b32 v223, 0
  ds_write_b32 v222, v223
  s_mov_b64 exec, -1
  s_waitcnt lgkmcnt(0)
  s_branch L_wdone
L_w1:
  s_cmp_eq_u32 s3, 1
  s_cbranch_scc0 L_w2
  s_lshl_b32 s92, s52, 5
  s_add_u32 s92, s92, s53
  s_lshl_b32 s92, s92, 10
  s_add_u32 s92, s92, 262144
  s_mov_b32 exec_hi, 0
  buffer_store_dwordx4 v[212:215], v1, s[24:27], s92 offen sc1
  s_mov_b64 exec, -1
  s_mov_b32 exec_lo, 0
  buffer_store_dwordx4 v[212:215], v1, s[24:27], s92 offen sc1
  s_mov_b64 exec, -1
  s_branch L_wdone
L_w2:
  s_cmp_eq_u32 s3, 2
  s_cbranch_scc0 L_w3
  v_lshlrev_b32 v219, 16, v13
  v_lshl_add_u32 v219, v12, 4, v219
  s_lshl_b32 s92, s52, 13
  s_lshl_b32 s94, s55, 11
  s_add_u32 s92, s92, s94
  s_lshl_b32 s94, s62, 8
  s_add_u32 s92, s92, s94
  s_add_u32 s92, s92, 2097152
  s_add_u32 s94, s92, 262144
  buffer_store_dwordx4 v[212:215], v219, s[24:27], s92 offen sc1
  buffer_store_dwordx4 v[212:215], v219, s[24:27], s94 offen sc1
  s_branch L_wdone
L_w3:
  s_lshl_b32 s92, s52, 5
  s_add_u32 s92, s92, s53
  s_lshl_b32 s94, s92, 7
  s_add_u32 s94, s94, 163840
  s_lshl_b32 s92, s92, 5
  s_add_u32 s92, s92, 131072
  s_mov_b64 exec, 1
  buffer_store_dwordx4 v[212:215], v1, s[24:27], s92 offen sc1
  s_mov_b64 exec, 2
  buffer_store_dwordx4 v[212:215], v1, s[24:27], s92 offen sc1
  s_mov_b64 exec, -1
L_wdone:
  s_barrier
  s_mov_b32 s20, s72
  s_and_b32 s21, s73, 0xffff
  s_mov_b32 s22, 4194304
  s_mov_b32 s23, 0x20000
  s_mov_b32 s40, s76
  s_and_b32 s41, s77, 0xffff
  s_mov_b32 s42, 3584
  s_mov_b32 s43, 0x20000
  s_mov_b32 s44, s78
  s_and_b32 s45, s79, 0xffff
  s_mov_b32 s46, 3584
  s_mov_b32 s47, 0x20000
  s_mov_b32 s48, s80
  s_and_b32 s49, s81, 0xffff
  s_mov_b32 s50, 3584
  s_mov_b32 s51, 0x20000
  s_mov_b32 s36, s84
  s_and_b32 s37, s85, 0xffff
  s_mov_b32 s38, 8192
  s_mov_b32 s39, 0x20000
  s_load_dword s59, s[82:83], 0
  s_waitcnt vmcnt(7)
  v_lshlrev_b32 v176, 16, v208
  v_and_b32 v177, 0xffff0000, v208
  v_lshlrev_b32 v178, 16, v209
  v_and_b32 v179, 0xffff0000, v209
  v_lshlrev_b32 v180, 16, v210
  v_and_b32 v181, 0xffff0000, v210
  v_lshlrev_b32 v182, 16, v211
  v_and_b32 v183, 0xffff0000, v211
  v_add_f32 v184, v176, v177
  v_add_f32 v185, v178, v179
  v_add_f32 v186, v180, v181
  v_add_f32 v187, v182, v183
  v_add_f32 v184, v184, v185
  v_add_f32 v186, v186, v187
  v_add_f32 v184, v184, v186
  s_nop 1
  v_add_f32_dpp v184, v184, v184 quad_perm:[1,0,3,2] row_mask:0xf bank_mask:0xf
  s_nop 1
  v_add_f32_dpp v184, v184, v184 quad_perm:[2,3,0,1] row_mask:0xf bank_mask:0xf
  s_nop 1
  v_add_f32_dpp v184, v184, v184 row_half_mirror row_mask:0xf bank_mask:0xf
  s_nop 1
  v_add_f32_dpp v184, v184, v184 row_mirror row_mask:0xf bank_mask:0xf
  v_mov_b32 v185, v184
  s_nop 1
  v_permlane16_swap_b32 v184, v185
  s_nop 0
  v_add_f32 v184, v184, v185
  v_mov_b32 v185, v184
  s_nop 1
  v_permlane32_swap_b32 v184, v185
  s_nop 0
  v_add_f32 v184, v184, v185
  v_mul_f32 v184, 0x3b000000, v184
  v_sub_f32 v188, v176, v184
  v_sub_f32 v189, v177, v184
  v_sub_f32 v190, v178, v184
  v_sub_f32 v191, v179, v184
  v_sub_f32 v192, v180, v184
  v_sub_f32 v193, v181, v184
  v_sub_f32 v194, v182, v184
  v_sub_f32 v195, v183, v184
  v_mul_f32 v185, v188, v188
  v_mul_f32 v186, v189, v189
  v_fmac_f32 v185, v190, v190
  v_fmac_f32 v186, v191, v191
  v_fmac_f32 v185, v192, v192
  v_fmac_f32 v186, v193, v193
  v_fmac_f32 v185, v194, v194
  v_fmac_f32 v186, v195, v195
  v_add_f32 v185, v185, v186
  s_nop 1
  v_add_f32_dpp v185, v185, v185 quad_perm:[1,0,3,2] row_mask:0xf bank_mask:0xf
  s_nop 1
  v_add_f32_dpp v185, v185, v185 quad_perm:[2,3,0,1] row_mask:0xf bank_mask:0xf
  s_nop 1
  v_add_f32_dpp v185, v185, v185 row_half_mirror row_mask:0xf bank_mask:0xf
  s_nop 1
  v_add_f32_dpp v185, v185, v185 row_mirror row_mask:0xf bank_mask:0xf
  v_mov_b32 v186, v185
  s_nop 1
  v_permlane16_swap_b32 v185, v186
  s_nop 0
  v_add_f32 v185, v185, v186
  v_mov_b32 v186, v185
  s_nop 1
  v_permlane32_swap_b32 v185, v186
  s_nop 0
  v_add_f32 v185, v185, v186
  v_mul_f32 v185, 0x3b000000, v185
  v_cvt_pk_bf16_f32 v186, v184, v185
  v_lshlrev_b32 v184, 16, v186
  v_and_b32 v185, 0xffff0000, v186
  v_add_f32 v185, 0x3727c5ac, v185
  v_cvt_pk_bf16_f32 v185, v185, v185
  v_lshlrev_b32 v185, 16, v185
  v_sqrt_f32 v185, v185
  s_nop 0
  v_cvt_pk_bf16_f32 v185, v185, v185
  v_lshlrev_b32 v185, 16, v185
  v_rcp_f32 v186, v185
  v_sub_f32 v188, v176, v184
  v_sub_f32 v189, v177, v184
  v_sub_f32 v190, v178, v184
  v_sub_f32 v191, v179, v184
  v_sub_f32 v192, v180, v184
  v_sub_f32 v193, v181, v184
  v_sub_f32 v194, v182, v184
  v_sub_f32 v195, v183, v184
  v_cvt_pk_bf16_f32 v187, v188, v189
  v_lshlrev_b32 v188, 16, v187
  v_and_b32 v189, 0xffff0000, v187
  v_cvt_pk_bf16_f32 v187, v190, v191
  v_lshlrev_b32 v190, 16, v187
  v_and_b32 v191, 0xffff0000, v187
  v_cvt_pk_bf16_f32 v187, v192, v193
  v_lshlrev_b32 v192, 16, v187
  v_and_b32 v193, 0xffff0000, v187
  v_cvt_pk_bf16_f32 v187, v194, v195
  v_lshlrev_b32 v194, 16, v187
  v_and_b32 v195, 0xffff0000, v187
  v_mul_f32 v176, v188, v186
  v_mul_f32 v177, v189, v186
  v_mul_f32 v178, v190, v186
  v_mul_f32 v179, v191, v186
  v_mul_f32 v180, v192, v186
  v_mul_f32 v181, v193, v186
  v_mul_f32 v182, v194, v186
  v_mul_f32 v183, v195, v186
  v_fma_f32 v188, -v176, v185, v188
  v_fma_f32 v189, -v177, v185, v189
  v_fma_f32 v190, -v178, v185, v190
  v_fma_f32 v191, -v179, v185, v191
  v_fma_f32 v192, -v180, v185, v192
  v_fma_f32 v193, -v181, v185, v193
  v_fma_f32 v194, -v182, v185, v194
  v_fma_f32 v195, -v183, v185, v195
  v_fmac_f32 v176, v188, v186
  v_fmac_f32 v177, v189, v186
  v_fmac_f32 v178, v190, v186
  v_fmac_f32 v179, v191, v186
  v_fmac_f32 v180, v192, v186
  v_fmac_f32 v181, v193, v186
  v_fmac_f32 v182, v194, v186
  v_fmac_f32 v183, v195, v186
  v_cvt_pk_bf16_f32 v184, v176, v177
  v_cvt_pk_bf16_f32 v185, v178, v179
  v_cvt_pk_bf16_f32 v186, v180, v181
  v_cvt_pk_bf16_f32 v187, v182, v183
  s_lshl_b32 s92, s3, 11
  s_add_u32 s92, s92, 147456
  v_lshl_add_u32 v188, v0, 4, s92
  ds_write_b128 v188, v[184:187]
  s_waitcnt vmcnt(6)
  v_lshlrev_b32 v176, 16, v232
  v_and_b32 v177, 0xffff0000, v232
  v_lshlrev_b32 v178, 16, v233
  v_and_b32 v179, 0xffff0000, v233
  v_lshlrev_b32 v180, 16, v234
  v_and_b32 v181, 0xffff0000, v234
  v_lshlrev_b32 v182, 16, v235
  v_and_b32 v183, 0xffff0000, v235
  v_add_f32 v184, v176, v177
  v_add_f32 v185, v178, v179
  v_add_f32 v186, v180, v181
  v_add_f32 v187, v182, v183
  v_add_f32 v184, v184, v185
  v_add_f32 v186, v186, v187
  v_add_f32 v184, v184, v186
  s_nop 1
  v_add_f32_dpp v184, v184, v184 quad_perm:[1,0,3,2] row_mask:0xf bank_mask:0xf
  s_nop 1
  v_add_f32_dpp v184, v184, v184 quad_perm:[2,3,0,1] row_mask:0xf bank_mask:0xf
  s_nop 1
  v_add_f32_dpp v184, v184, v184 row_half_mirror row_mask:0xf bank_mask:0xf
  s_nop 1
  v_add_f32_dpp v184, v184, v184 row_mirror row_mask:0xf bank_mask:0xf
  v_mov_b32 v185, v184
  s_nop 1
  v_permlane16_swap_b32 v184, v185
  s_nop 0
  v_add_f32 v184, v184, v185
  v_mov_b32 v185, v184
  s_nop 1
  v_permlane32_swap_b32 v184, v185
  s_nop 0
  v_add_f32 v184, v184, v185
  v_mul_f32 v184, 0x3b000000, v184
  v_sub_f32 v188, v176, v184
  v_sub_f32 v189, v177, v184
  v_sub_f32 v190, v178, v184
  v_sub_f32 v191, v179, v184
  v_sub_f32 v192, v180, v184
  v_sub_f32 v193, v181, v184
  v_sub_f32 v194, v182, v184
  v_sub_f32 v195, v183, v184
  v_mul_f32 v185, v188, v188
  v_mul_f32 v186, v189, v189
  v_fmac_f32 v185, v190, v190
  v_fmac_f32 v186, v191, v191
  v_fmac_f32 v185, v192, v192
  v_fmac_f32 v186, v193, v193
  v_fmac_f32 v185, v194, v194
  v_fmac_f32 v186, v195, v195
  v_add_f32 v185, v185, v186
  s_nop 1
  v_add_f32_dpp v185, v185, v185 quad_perm:[1,0,3,2] row_mask:0xf bank_mask:0xf
  s_nop 1
  v_add_f32_dpp v185, v185, v185 quad_perm:[2,3,0,1] row_mask:0xf bank_mask:0xf
  s_nop 1
  v_add_f32_dpp v185, v185, v185 row_half_mirror row_mask:0xf bank_mask:0xf
  s_nop 1
  v_add_f32_dpp v185, v185, v185 row_mirror row_mask:0xf bank_mask:0xf
  v_mov_b32 v186, v185
  s_nop 1
  v_permlane16_swap_b32 v185, v186
  s_nop 0
  v_add_f32 v185, v185, v186
  v_mov_b32 v186, v185
  s_nop 1
  v_permlane32_swap_b32 v185, v186
  s_nop 0
  v_add_f32 v185, v185, v186
  v_mul_f32 v185, 0x3b000000, v185
  v_cvt_pk_bf16_f32 v186, v184, v185
  v_lshlrev_b32 v184, 16, v186
  v_and_b32 v185, 0xffff0000, v186
  v_add_f32 v185, 0x3727c5ac, v185
  v_cvt_pk_bf16_f32 v185, v185, v185
  v_lshlrev_b32 v185, 16, v185
  v_sqrt_f32 v185, v185
  s_nop 0
  v_cvt_pk_bf16_f32 v185, v185, v185
  v_lshlrev_b32 v185, 16, v185
  v_rcp_f32 v186, v185
  v_sub_f32 v188, v176, v184
  v_sub_f32 v189, v177, v184
  v_sub_f32 v190, v178, v184
  v_sub_f32 v191, v179, v184
  v_sub_f32 v192, v180, v184
  v_sub_f32 v193, v181, v184
  v_sub_f32 v194, v182, v184
  v_sub_f32 v195, v183, v184
  v_cvt_pk_bf16_f32 v187, v188, v189
  v_lshlrev_b32 v188, 16, v187
  v_and_b32 v189, 0xffff0000, v187
  v_cvt_pk_bf16_f32 v187, v190, v191
  v_lshlrev_b32 v190, 16, v187
  v_and_b32 v191, 0xffff0000, v187
  v_cvt_pk_bf16_f32 v187, v192, v193
  v_lshlrev_b32 v192, 16, v187
  v_and_b32 v193, 0xffff0000, v187
  v_cvt_pk_bf16_f32 v187, v194, v195
  v_lshlrev_b32 v194, 16, v187
  v_and_b32 v195, 0xffff0000, v187
  v_mul_f32 v176, v188, v186
  v_mul_f32 v177, v189, v186
  v_mul_f32 v178, v190, v186
  v_mul_f32 v179, v191, v186
  v_mul_f32 v180, v192, v186
  v_mul_f32 v181, v193, v186
  v_mul_f32 v182, v194, v186
  v_mul_f32 v183, v195, v186
  v_fma_f32 v188, -v176, v185, v188
  v_fma_f32 v189, -v177, v185, v189
  v_fma_f32 v190, -v178, v185, v190
  v_fma_f32 v191, -v179, v185, v191
  v_fma_f32 v192, -v180, v185, v192
  v_fma_f32 v193, -v181, v185, v193
  v_fma_f32 v194, -v182, v185, v194
  v_fma_f32 v195, -v183, v185, v195
  v_fmac_f32 v176, v188, v186
  v_fmac_f32 v177, v189, v186
  v_fmac_f32 v178, v190, v186
  v_fmac_f32 v179, v191, v186
  v_fmac_f32 v180, v192, v186
  v_fmac_f32 v181, v193, v186
  v_fmac_f32 v182, v194, v186
  v_fmac_f32 v183, v195, v186
  v_cvt_pk_bf16_f32 v184, v176, v177
  v_cvt_pk_bf16_f32 v185, v178, v179
  v_cvt_pk_bf16_f32 v186, v180, v181
  v_cvt_pk_bf16_f32 v187, v182, v183
  s_lshl_b32 s92, s3, 11
  s_add_u32 s92, s92, 148480
  v_lshl_add_u32 v188, v0, 4, s92
  ds_write_b128 v188, v[184:187]
  v_mov_b32 v189, 158912
  v_mov_b32 v190, 1
  s_waitcnt lgkmcnt(0)
  s_mov_b64 exec, 1
  ds_add_u32 v189, v190
  s_mov_b64 exec, -1
  v_lshlrev_b32 v2, 8, v13
  v_lshl_add_u32 v2, v12, 3, v2
  v_add_u32 v2, s57, v2
  v_and_b32 v184, 7, v12
  v_lshlrev_b32 v184, 10, v184
  v_lshl_add_u32 v184, v13, 4, v184
  s_lshl_b32 s92, s3, 8
  s_add_u32 s92, s92, 147456
  v_add_u32 v184, s92, v184
  v_lshrrev_b32 v224, 3, v0
  v_and_b32 v224, 1, v224
  v_lshlrev_b32 v225, 13, v13
  v_lshl_add_u32 v225, v224, 12, v225
  v_and_b32 v224, 7, v0
  v_lshl_add_u32 v225, v224, 4, v225
  s_waitcnt vmcnt(2)
  ds_read_b64_tr_b16 v[144:145], v2 offset:0
  ds_read_b64_tr_b16 v[146:147], v2 offset:128
  ds_read_b64_tr_b16 v[148:149], v2 offset:1024
  ds_read_b64_tr_b16 v[150:151], v2 offset:1152
  ds_read_b64_tr_b16 v[152:153], v2 offset:2048
  ds_read_b64_tr_b16 v[154:155], v2 offset:2176
  ds_read_b64_tr_b16 v[156:157], v2 offset:3072
  ds_read_b64_tr_b16 v[158:159], v2 offset:3200
  v_mov_b32 v192, 158912
  s_mov_b32 s63, 800000
Lw_1:
  ds_read_b32 v193, v192
  s_waitcnt lgkmcnt(0)
  v_readfirstlane_b32 s99, v193
  s_nop 0
  s_cmp_ge_u32 s99, 4
  s_cbranch_scc1 Lwd_2
  s_sub_u32 s63, s63, 1
  s_cbranch_scc0 Lw_1
Lwd_2:
  ds_read_b128 v[16:19], v184 offset:0
  ds_read_b128 v[20:23], v184 offset:64
  ds_read_b128 v[24:27], v184 offset:128
  ds_read_b128 v[28:31], v184 offset:192
  s_lshl_b32 s92, s3, 9
  s_add_u32 s92, s92, 155648
  v_add_u32 v187, s92, v1
  s_waitcnt lgkmcnt(0)
  v_mfma_f32_16x16x32_bf16 v[196:199], v[16:19], v[144:147], 0
  v_mfma_f32_16x16x32_bf16 v[196:199], v[20:23], v[148:151], v[196:199]
  v_mfma_f32_16x16x32_bf16 v[196:199], v[24:27], v[152:155], v[196:199]
  v_mfma_f32_16x16x32_bf16 v[196:199], v[28:31], v[156:159], v[196:199]
  s_lshl_b32 s93, s52, 9
  s_lshl_b32 s94, s55, 7
  s_add_u32 s93, s93, s94
  s_add_u32 s93, s93, s3
  s_lshl_b32 s93, s93, 10
  s_lshl_b32 s94, s62, 7
  s_add_u32 s93, s93, s94
  s_mov_b32 m0, s57
  s_nop 3
  s_mov_b32 exec_hi, 0
  ds_write_b128 v187, v[196:199]
  s_mov_b64 exec, -1
  s_waitcnt vmcnt(0)
  s_cmp_eq_u32 s3, 0
  s_cbranch_scc0 L_nonce_done
  v_readfirstlane_b32 s92, v220
  s_nop 0
  s_cmp_eq_u32 s92, 0
  s_cselect_b32 s92, s60, s92
  v_mov_b32 v190, s92
  v_mov_b32 v191, 158932
  ds_write_b32 v191, v190
L_nonce_done:
  v_mov_b32 v192, 158916
  v_mov_b32 v193, 1
  s_waitcnt lgkmcnt(0)
  s_mov_b64 exec, 1
  ds_add_u32 v192, v193
  s_mov_b64 exec, -1
  s_lshr_b32 s92, s3, 1
  s_lshl_b32 s92, s92, 8
  s_and_b32 s94, s3, 1
  s_lshl_b32 s94, s94, 3
  s_add_u32 s92, s92, s94
  s_add_u32 s92, s92, 155648
  v_and_b32 v184, 1, v13
  v_lshlrev_b32 v184, 10, v184
  v_lshl_add_u32 v184, v12, 4, v184
  v_lshrrev_b32 v185, 1, v13
  v_lshl_add_u32 v184, v185, 2, v184
  v_add_u32 v184, s92, v184
  v_lshlrev_b32 v187, 14, v185
  v_lshl_add_u32 v187, v12, 2, v187
  s_lshl_b32 s95, s3, 15
  s_lshl_b32 s94, s52, 11
  s_add_u32 s95, s95, s94
  s_lshl_b32 s94, s53, 6
  s_add_u32 s95, s95, s94
  v_mov_b32 v191, 158932
  v_mov_b32 v192, 158916
  s_mov_b32 s63, 800000
Lw_3:
  ds_read_b32 v193, v192
  s_waitcnt lgkmcnt(0)
  v_readfirstlane_b32 s99, v193
  s_nop 0
  s_cmp_ge_u32 s99, 4
  s_cbranch_scc1 Lwd_4
  s_sub_u32 s63, s63, 1
  s_cbranch_scc0 Lw_3
Lwd_4:
  ds_read_b32 v185, v184
  ds_read_b32 v186, v184 offset:512
  ds_read_b32 v189, v191
  s_waitcnt lgkmcnt(0)
  v_add_f32 v185, v185, v186
  v_mov_b32 v186, v185
  s_nop 1
  v_permlane16_swap_b32 v185, v186
  s_nop 0
  v_add_f32 v185, v185, v186
  s_nop 1
  v_mov_b32_dpp v186, v185 quad_perm:[1,0,3,2] row_mask:0xf bank_mask:0xf
  v_readfirstlane_b32 s58, v189
  v_cvt_pk_bf16_f32 v188, v185, v186
  s_mov_b32 exec_lo, 0x5555
  s_mov_b32 exec_hi, 0x5555
  buffer_store_dwordx2 v[188:189], v187, s[24:27], s95 offen sc1
  s_mov_b64 exec, -1
  v_lshlrev_b32 v3, 3, v0
  s_mov_b32 s69, 0x00003f80
  s_mov_b32 s70, 0x3f800000
  s_mov_b32 s68, 0x3fb8aa3b
  s_lshl_b32 s59, s59, 16
  s_cmp_eq_u32 s3, 0
  s_cbranch_scc0 L_noqpoll
  s_lshl_b32 s96, s54, 14
  s_lshl_b32 s94, s52, 11
  s_add_u32 s96, s96, s94
  v_add_u32 v190, 157696, v3
  s_waitcnt vmcnt(0)
  s_sleep 16
  s_mov_b32 s63, 200000
  s_mov_b64 vcc, -1
L_qml:
  s_mov_b64 exec, vcc
  buffer_load_dwordx4 v[86:89], v1, s[24:27], s96 offen sc1
  buffer_load_dwordx4 v[90:93], v1, s[24:27], s96 offen offset:1024 sc1
  s_mov_b64 exec, -1
  s_waitcnt vmcnt(0)
  v_xor_b32 v184, s58, v87
  v_xor_b32 v185, s58, v89
  v_xor_b32 v186, s58, v91
  v_xor_b32 v187, s58, v93
  v_or3_b32 v184, v184, v185, v186
  v_or_b32 v184, v184, v187
  v_cmp_ne_u32 vcc, 0, v184
  s_cbranch_vccz L_qmd
  s_sleep 4
  s_sub_u32 s63, s63, 1
  s_cbranch_scc0 L_qml
L_qmd:
  v_mov_b32 v87, v88
  v_mov_b32 v91, v92
  ds_write_b64 v190, v[86:87]
  ds_write_b64 v190, v[90:91] offset:512
  v_mov_b32 v192, 158920
  v_mov_b32 v193, 1
  s_waitcnt lgkmcnt(0)
  s_mov_b64 exec, 1
  ds_add_u32 v192, v193
  s_mov_b64 exec, -1
  s_waitcnt vmcnt(0)
L_noqpoll:
  s_mov_b32 s5, s93
  v_and_b32 v8, 31, v0
  v_lshlrev_b32 v8, 3, v8
  v_lshrrev_b32 v190, 5, v0
  v_lshl_add_u32 v8, v190, 2, v8
  s_cmp_lt_u32 s2, 8
  s_cbranch_scc0 L_noxf
  s_lshl_b32 s92, s2, 10
  s_lshl_b32 s94, s3, 8
  s_add_u32 s92, s92, s94
  buffer_load_dword v4, v8, s[28:31], s92 offen
L_noxf:
  s_cmp_eq_u32 s3, 0
  s_cbranch_scc1 L_gskip
  buffer_load_dwordx4 v[86:89], v1, s[40:43], 0 offen offset:0
  buffer_load_dwordx4 v[90:93], v1, s[40:43], 0 offen offset:1024
  buffer_load_dwordx4 v[94:97], v1, s[40:43], 0 offen offset:2048
  buffer_load_dwordx2 v[98:99], v3, s[40:43], 0 offen offset:3072
  buffer_load_dwordx4 v[100:103], v1, s[44:47], 0 offen offset:0
  buffer_load_dwordx4 v[104:107], v1, s[44:47], 0 offen offset:1024
  buffer_load_dwordx4 v[108:111], v1, s[44:47], 0 offen offset:2048
  buffer_load_dwordx2 v[112:113], v3, s[44:47], 0 offen offset:3072
  buffer_load_dwordx4 v[72:75], v1, s[48:51], 0 offen offset:0
  buffer_load_dwordx4 v[76:79], v1, s[48:51], 0 offen offset:1024
  buffer_load_dwordx4 v[80:83], v1, s[48:51], 0 offen offset:2048
  buffer_load_dwordx2 v[84:85], v3, s[48:51], 0 offen offset:3072
  s_lshl_b32 s92, s3, 11
  s_sub_u32 s92, s92, 2048
  s_add_u32 s98, s92, s2
  s_add_u32 s93, s98, 0
  s_cmp_ge_u32 s93, 3072
  s_cselect_b32 s94, 29696, 0
  s_add_u32 s93, s93, s94
  s_add_u32 s93, s93, 13824
  s_lshl_b32 s93, s93, 16
  v_mov_b32 v174, s93
  v_mov_b32 v166, 0
  s_add_u32 s93, s98, 256
  s_cmp_ge_u32 s93, 3072
  s_cselect_b32 s94, 29696, 0
  s_add_u32 s93, s93, s94
  s_add_u32 s93, s93, 13824
  s_lshl_b32 s93, s93, 16
  v_mov_b32 v175, s93
  v_mov_b32 v167, 0
  s_add_u32 s93, s98, 512
  s_cmp_ge_u32 s93, 3072
  s_cselect_b32 s94, 29696, 0
  s_add_u32 s93, s93, s94
  s_add_u32 s93, s93, 13824
  s_lshl_b32 s93, s93, 16
  v_mov_b32 v176, s93
  v_mov_b32 v168, 0
  s_add_u32 s93, s98, 768
  s_cmp_ge_u32 s93, 3072
  s_cselect_b32 s94, 29696, 0
  s_add_u32 s93, s93, s94
  s_add_u32 s93, s93, 13824
  s_lshl_b32 s93, s93, 16
  v_mov_b32 v177, s93
  v_mov_b32 v169, 0
  s_add_u32 s93, s98, 1024
  s_cmp_ge_u32 s93, 3072
  s_cselect_b32 s94, 29696, 0
  s_add_u32 s93, s93, s94
  s_add_u32 s93, s93, 13824
  s_lshl_b32 s93, s93, 16
  v_mov_b32 v178, s93
  v_mov_b32 v170, 0
  s_add_u32 s93, s98, 1280
  s_cmp_ge_u32 s93, 3072
  s_cselect_b32 s94, 29696, 0
  s_add_u32 s93, s93, s94
  s_add_u32 s93, s93, 13824
  s_lshl_b32 s93, s93, 16
  v_mov_b32 v179, s93
  v_mov_b32 v171, 0
  s_add_u32 s93, s98, 1536
  s_cmp_ge_u32 s93, 3072
  s_cselect_b32 s94, 29696, 0
  s_add_u32 s93, s93, s94
  s_add_u32 s93, s93, 13824
  s_lshl_b32 s93, s93, 16
  v_mov_b32 v180, s93
  v_mov_b32 v172, 0
  s_add_u32 s93, s98, 1792
  s_cmp_ge_u32 s93, 3072
  s_cselect_b32 s94, 29696, 0
  s_add_u32 s93, s93, s94
  s_add_u32 s93, s93, 13824
  s_lshl_b32 s93, s93, 16
  v_mov_b32 v181, s93
  v_mov_b32 v173, 0
  s_setprio 0
  s_waitcnt vmcnt(0)
  v_lshlrev_b32 v16, 16, v86
  v_and_b32 v17, 0xffff0000, v86
  v_lshlrev_b32 v18, 16, v87
  v_and_b32 v19, 0xffff0000, v87
  v_lshlrev_b32 v20, 16, v88
  v_and_b32 v21, 0xffff0000, v88
  v_lshlrev_b32 v22, 16, v89
  v_and_b32 v23, 0xffff0000, v89
  v_lshlrev_b32 v24, 16, v90
  v_and_b32 v25, 0xffff0000, v90
  v_lshlrev_b32 v26, 16, v91
  v_and_b32 v27, 0xffff0000, v91
  v_lshlrev_b32 v28, 16, v92
  v_and_b32 v29, 0xffff0000, v92
  v_lshlrev_b32 v30, 16, v93
  v_and_b32 v31, 0xffff0000, v93
  v_lshlrev_b32 v32, 16, v94
  v_and_b32 v33, 0xffff0000, v94
  v_lshlrev_b32 v34, 16, v95
  v_and_b32 v35, 0xffff0000, v95
  v_lshlrev_b32 v36, 16, v96
  v_and_b32 v37, 0xffff0000, v96
  v_lshlrev_b32 v38, 16, v97
  v_and_b32 v39, 0xffff0000, v97
  v_lshlrev_b32 v40, 16, v98
  v_and_b32 v41, 0xffff0000, v98
  v_lshlrev_b32 v42, 16, v99
  v_and_b32 v43, 0xffff0000, v99
  v_lshlrev_b32 v44, 16, v100
  v_and_b32 v45, 0xffff0000, v100
  v_lshlrev_b32 v46, 16, v101
  v_and_b32 v47, 0xffff0000, v101
  v_lshlrev_b32 v48, 16, v102
  v_and_b32 v49, 0xffff0000, v102
  v_lshlrev_b32 v50, 16, v103
  v_and_b32 v51, 0xffff0000, v103
  v_lshlrev_b32 v52, 16, v104
  v_and_b32 v53, 0xffff0000, v104
  v_lshlrev_b32 v54, 16, v105
  v_and_b32 v55, 0xffff0000, v105
  v_lshlrev_b32 v56, 16, v106
  v_and_b32 v57, 0xffff0000, v106
  v_lshlrev_b32 v58, 16, v107
  v_and_b32 v59, 0xffff0000, v107
  v_lshlrev_b32 v60, 16, v108
  v_and_b32 v61, 0xffff0000, v108
  v_lshlrev_b32 v62, 16, v109
  v_and_b32 v63, 0xffff0000, v109
  v_lshlrev_b32 v64, 16, v110
  v_and_b32 v65, 0xffff0000, v110
  v_lshlrev_b32 v66, 16, v111
  v_and_b32 v67, 0xffff0000, v111
  v_lshlrev_b32 v68, 16, v112
  v_and_b32 v69, 0xffff0000, v112
  v_lshlrev_b32 v70, 16, v113
  v_and_b32 v71, 0xffff0000, v113
  v_mov_b32 v182, 0xc0135761
  v_mul_f32 v86, v174, v16
  v_mul_f32 v87, v174, v17
  v_mul_f32 v88, v174, v18
  v_mul_f32 v89, v174, v19
  v_mul_f32 v90, v175, v16
  v_mul_f32 v91, v175, v17
  v_mul_f32 v92, v175, v18
  v_mul_f32 v93, v175, v19
  v_mul_f32 v94, v176, v16
  v_mul_f32 v95, v176, v17
  v_mul_f32 v96, v176, v18
  v_mul_f32 v97, v176, v19
  v_mul_f32 v98, v177, v16
  v_mul_f32 v99, v177, v17
  v_mul_f32 v100, v177, v18
  v_mul_f32 v101, v177, v19
  v_mul_f32 v102, v178, v16
  v_mul_f32 v103, v178, v17
  v_mul_f32 v104, v178, v18
  v_mul_f32 v105, v178, v19
  v_mul_f32 v106, v179, v16
  v_mul_f32 v107, v179, v17
  v_mul_f32 v108, v179, v18
  v_mul_f32 v109, v179, v19
  v_mul_f32 v110, v180, v16
  v_mul_f32 v111, v180, v17
  v_mul_f32 v112, v180, v18
  v_mul_f32 v113, v180, v19
  v_mul_f32 v114, v181, v16
  v_mul_f32 v115, v181, v17
  v_mul_f32 v116, v181, v18
  v_mul_f32 v117, v181, v19
  v_cvt_pk_bf16_f32 v150, v86, v87
  v_cvt_pk_bf16_f32 v151, v88, v89
  v_cvt_pk_bf16_f32 v152, v90, v91
  v_cvt_pk_bf16_f32 v153, v92, v93
  v_cvt_pk_bf16_f32 v154, v94, v95
  v_cvt_pk_bf16_f32 v155, v96, v97
  v_cvt_pk_bf16_f32 v156, v98, v99
  v_cvt_pk_bf16_f32 v157, v100, v101
  v_cvt_pk_bf16_f32 v158, v102, v103
  v_cvt_pk_bf16_f32 v159, v104, v105
  v_cvt_pk_bf16_f32 v160, v106, v107
  v_cvt_pk_bf16_f32 v161, v108, v109
  v_cvt_pk_bf16_f32 v162, v110, v111
  v_cvt_pk_bf16_f32 v163, v112, v113
  v_cvt_pk_bf16_f32 v164, v114, v115
  v_cvt_pk_bf16_f32 v165, v116, v117
  v_dot2_f32_bf16 v86, v150, s69, v44
  v_dot2_f32_bf16 v87, v150, s70, v45
  v_dot2_f32_bf16 v88, v151, s69, v46
  v_dot2_f32_bf16 v89, v151, s70, v47
  v_dot2_f32_bf16 v90, v152, s69, v44
  v_dot2_f32_bf16 v91, v152, s70, v45
  v_dot2_f32_bf16 v92, v153, s69, v46
  v_dot2_f32_bf16 v93, v153, s70, v47
  v_dot2_f32_bf16 v94, v154, s69, v44
  v_dot2_f32_bf16 v95, v154, s70, v45
  v_dot2_f32_bf16 v96, v155, s69, v46
  v_dot2_f32_bf16 v97, v155, s70, v47
  v_dot2_f32_bf16 v98, v156, s69, v44
  v_dot2_f32_bf16 v99, v156, s70, v45
  v_dot2_f32_bf16 v100, v157, s69, v46
  v_dot2_f32_bf16 v101, v157, s70, v47
  v_dot2_f32_bf16 v102, v158, s69, v44
  v_dot2_f32_bf16 v103, v158, s70, v45
  v_dot2_f32_bf16 v104, v159, s69, v46
  v_dot2_f32_bf16 v105, v159, s70, v47
  v_dot2_f32_bf16 v106, v160, s69, v44
  v_dot2_f32_bf16 v107, v160, s70, v45
  v_dot2_f32_bf16 v108, v161, s69, v46
  v_dot2_f32_bf16 v109, v161, s70, v47
  v_dot2_f32_bf16 v110, v162, s69, v44
  v_dot2_f32_bf16 v111, v162, s70, v45
  v_dot2_f32_bf16 v112, v163, s69, v46
  v_dot2_f32_bf16 v113, v163, s70, v47
  v_dot2_f32_bf16 v114, v164, s69, v44
  v_dot2_f32_bf16 v115, v164, s70, v45
  v_dot2_f32_bf16 v116, v165, s69, v46
  v_dot2_f32_bf16 v117, v165, s70, v47
  v_cvt_pk_bf16_f32 v150, v86, v87
  v_cvt_pk_bf16_f32 v151, v88, v89
  v_cvt_pk_bf16_f32 v152, v90, v91
  v_cvt_pk_bf16_f32 v153, v92, v93
  v_cvt_pk_bf16_f32 v154, v94, v95
  v_cvt_pk_bf16_f32 v155, v96, v97
  v_cvt_pk_bf16_f32 v156, v98, v99
  v_cvt_pk_bf16_f32 v157, v100, v101
  v_cvt_pk_bf16_f32 v158, v102, v103
  v_cvt_pk_bf16_f32 v159, v104, v105
  v_cvt_pk_bf16_f32 v160, v106, v107
  v_cvt_pk_bf16_f32 v161, v108, v109
  v_cvt_pk_bf16_f32 v162, v110, v111
  v_cvt_pk_bf16_f32 v163, v112, v113
  v_cvt_pk_bf16_f32 v164, v114, v115
  v_cvt_pk_bf16_f32 v165, v116, v117
  v_lshlrev_b32 v86, 16, v150
  v_and_b32 v87, 0xffff0000, v150
  v_lshlrev_b32 v88, 16, v151
  v_and_b32 v89, 0xffff0000, v151
  v_lshlrev_b32 v90, 16, v152
  v_and_b32 v91, 0xffff0000, v152
  v_lshlrev_b32 v92, 16, v153
  v_and_b32 v93, 0xffff0000, v153
  v_lshlrev_b32 v94, 16, v154
  v_and_b32 v95, 0xffff0000, v154
  v_lshlrev_b32 v96, 16, v155
  v_and_b32 v97, 0xffff0000, v155
  v_lshlrev_b32 v98, 16, v156
  v_and_b32 v99, 0xffff0000, v156
  v_lshlrev_b32 v100, 16, v157
  v_and_b32 v101, 0xffff0000, v157
  v_lshlrev_b32 v102, 16, v158
  v_and_b32 v103, 0xffff0000, v158
  v_lshlrev_b32 v104, 16, v159
  v_and_b32 v105, 0xffff0000, v159
  v_lshlrev_b32 v106, 16, v160
  v_and_b32 v107, 0xffff0000, v160
  v_lshlrev_b32 v108, 16, v161
  v_and_b32 v109, 0xffff0000, v161
  v_lshlrev_b32 v110, 16, v162
  v_and_b32 v111, 0xffff0000, v162
  v_lshlrev_b32 v112, 16, v163
  v_and_b32 v113, 0xffff0000, v163
  v_lshlrev_b32 v114, 16, v164
  v_and_b32 v115, 0xffff0000, v164
  v_lshlrev_b32 v116, 16, v165
  v_and_b32 v117, 0xffff0000, v165
  v_mul_f32 v118, v86, v86
  v_mul_f32 v119, v87, v87
  v_mul_f32 v120, v88, v88
  v_mul_f32 v121, v89, v89
  v_mul_f32 v122, v90, v90
  v_mul_f32 v123, v91, v91
  v_mul_f32 v124, v92, v92
  v_mul_f32 v125, v93, v93
  v_mul_f32 v126, v94, v94
  v_mul_f32 v127, v95, v95
  v_mul_f32 v128, v96, v96
  v_mul_f32 v129, v97, v97
  v_mul_f32 v130, v98, v98
  v_mul_f32 v131, v99, v99
  v_mul_f32 v132, v100, v100
  v_mul_f32 v133, v101, v101
  v_mul_f32 v134, v102, v102
  v_mul_f32 v135, v103, v103
  v_mul_f32 v136, v104, v104
  v_mul_f32 v137, v105, v105
  v_mul_f32 v138, v106, v106
  v_mul_f32 v139, v107, v107
  v_mul_f32 v140, v108, v108
  v_mul_f32 v141, v109, v109
  v_mul_f32 v142, v110, v110
  v_mul_f32 v143, v111, v111
  v_mul_f32 v144, v112, v112
  v_mul_f32 v145, v113, v113
  v_mul_f32 v146, v114, v114
  v_mul_f32 v147, v115, v115
  v_mul_f32 v148, v116, v116
  v_mul_f32 v149, v117, v117
  v_fmamk_f32 v118, v118, 0xbdd2d3e8, v182
  v_fmamk_f32 v119, v119, 0xbdd2d3e8, v182
  v_fmamk_f32 v120, v120, 0xbdd2d3e8, v182
  v_fmamk_f32 v121, v121, 0xbdd2d3e8, v182
  v_fmamk_f32 v122, v122, 0xbdd2d3e8, v182
  v_fmamk_f32 v123, v123, 0xbdd2d3e8, v182
  v_fmamk_f32 v124, v124, 0xbdd2d3e8, v182
  v_fmamk_f32 v125, v125, 0xbdd2d3e8, v182
  v_fmamk_f32 v126, v126, 0xbdd2d3e8, v182
  v_fmamk_f32 v127, v127, 0xbdd2d3e8, v182
  v_fmamk_f32 v128, v128, 0xbdd2d3e8, v182
  v_fmamk_f32 v129, v129, 0xbdd2d3e8, v182
  v_fmamk_f32 v130, v130, 0xbdd2d3e8, v182
  v_fmamk_f32 v131, v131, 0xbdd2d3e8, v182
  v_fmamk_f32 v132, v132, 0xbdd2d3e8, v182
  v_fmamk_f32 v133, v133, 0xbdd2d3e8, v182
  v_fmamk_f32 v134, v134, 0xbdd2d3e8, v182
  v_fmamk_f32 v135, v135, 0xbdd2d3e8, v182
  v_fmamk_f32 v136, v136, 0xbdd2d3e8, v182
  v_fmamk_f32 v137, v137, 0xbdd2d3e8, v182
  v_fmamk_f32 v138, v138, 0xbdd2d3e8, v182
  v_fmamk_f32 v139, v139, 0xbdd2d3e8, v182
  v_fmamk_f32 v140, v140, 0xbdd2d3e8, v182
  v_fmamk_f32 v141, v141, 0xbdd2d3e8, v182
  v_fmamk_f32 v142, v142, 0xbdd2d3e8, v182
  v_fmamk_f32 v143, v143, 0xbdd2d3e8, v182
  v_fmamk_f32 v144, v144, 0xbdd2d3e8, v182
  v_fmamk_f32 v145, v145, 0xbdd2d3e8, v182
  v_fmamk_f32 v146, v146, 0xbdd2d3e8, v182
  v_fmamk_f32 v147, v147, 0xbdd2d3e8, v182
  v_fmamk_f32 v148, v148, 0xbdd2d3e8, v182
  v_fmamk_f32 v149, v149, 0xbdd2d3e8, v182
  v_mul_f32 v118, v86, v118
  v_mul_f32 v119, v87, v119
  v_mul_f32 v120, v88, v120
  v_mul_f32 v121, v89, v121
  v_mul_f32 v122, v90, v122
  v_mul_f32 v123, v91, v123
  v_mul_f32 v124, v92, v124
  v_mul_f32 v125, v93, v125
  v_mul_f32 v126, v94, v126
  v_mul_f32 v127, v95, v127
  v_mul_f32 v128, v96, v128
  v_mul_f32 v129, v97, v129
  v_mul_f32 v130, v98, v130
  v_mul_f32 v131, v99, v131
  v_mul_f32 v132, v100, v132
  v_mul_f32 v133, v101, v133
  v_mul_f32 v134, v102, v134
  v_mul_f32 v135, v103, v135
  v_mul_f32 v136, v104, v136
  v_mul_f32 v137, v105, v137
  v_mul_f32 v138, v106, v138
  v_mul_f32 v139, v107, v139
  v_mul_f32 v140, v108, v140
  v_mul_f32 v141, v109, v141
  v_mul_f32 v142, v110, v142
  v_mul_f32 v143, v111, v143
  v_mul_f32 v144, v112, v144
  v_mul_f32 v145, v113, v145
  v_mul_f32 v146, v114, v146
  v_mul_f32 v147, v115, v147
  v_mul_f32 v148, v116, v148
  v_mul_f32 v149, v117, v149
  v_exp_f32 v118, v118
  v_exp_f32 v119, v119
  v_exp_f32 v120, v120
  v_exp_f32 v121, v121
  v_exp_f32 v122, v122
  v_exp_f32 v123, v123
  v_exp_f32 v124, v124
  v_exp_f32 v125, v125
  v_exp_f32 v126, v126
  v_exp_f32 v127, v127
  v_exp_f32 v128, v128
  v_exp_f32 v129, v129
  v_exp_f32 v130, v130
  v_exp_f32 v131, v131
  v_exp_f32 v132, v132
  v_exp_f32 v133, v133
  v_exp_f32 v134, v134
  v_exp_f32 v135, v135
  v_exp_f32 v136, v136
  v_exp_f32 v137, v137
  v_exp_f32 v138, v138
  v_exp_f32 v139, v139
  v_exp_f32 v140, v140
  v_exp_f32 v141, v141
  v_exp_f32 v142, v142
  v_exp_f32 v143, v143
  v_exp_f32 v144, v144
  v_exp_f32 v145, v145
  v_exp_f32 v146, v146
  v_exp_f32 v147, v147
  v_exp_f32 v148, v148
  v_exp_f32 v149, v149
  v_add_f32 v118, 1.0, v118
  v_add_f32 v119, 1.0, v119
  v_add_f32 v120, 1.0, v120
  v_add_f32 v121, 1.0, v121
  v_add_f32 v122, 1.0, v122
  v_add_f32 v123, 1.0, v123
  v_add_f32 v124, 1.0, v124
  v_add_f32 v125, 1.0, v125
  v_add_f32 v126, 1.0, v126
  v_add_f32 v127, 1.0, v127
  v_add_f32 v128, 1.0, v128
  v_add_f32 v129, 1.0, v129
  v_add_f32 v130, 1.0, v130
  v_add_f32 v131, 1.0, v131
  v_add_f32 v132, 1.0, v132
  v_add_f32 v133, 1.0, v133
  v_add_f32 v134, 1.0, v134
  v_add_f32 v135, 1.0, v135
  v_add_f32 v136, 1.0, v136
  v_add_f32 v137, 1.0, v137
  v_add_f32 v138, 1.0, v138
  v_add_f32 v139, 1.0, v139
  v_add_f32 v140, 1.0, v140
  v_add_f32 v141, 1.0, v141
  v_add_f32 v142, 1.0, v142
  v_add_f32 v143, 1.0, v143
  v_add_f32 v144, 1.0, v144
  v_add_f32 v145, 1.0, v145
  v_add_f32 v146, 1.0, v146
  v_add_f32 v147, 1.0, v147
  v_add_f32 v148, 1.0, v148
  v_add_f32 v149, 1.0, v149
  v_rcp_f32 v118, v118
  v_rcp_f32 v119, v119
  v_rcp_f32 v120, v120
  v_rcp_f32 v121, v121
  v_rcp_f32 v122, v122
  v_rcp_f32 v123, v123
  v_rcp_f32 v124, v124
  v_rcp_f32 v125, v125
  v_rcp_f32 v126, v126
  v_rcp_f32 v127, v127
  v_rcp_f32 v128, v128
  v_rcp_f32 v129, v129
  v_rcp_f32 v130, v130
  v_rcp_f32 v131, v131
  v_rcp_f32 v132, v132
  v_rcp_f32 v133, v133
  v_rcp_f32 v134, v134
  v_rcp_f32 v135, v135
  v_rcp_f32 v136, v136
  v_rcp_f32 v137, v137
  v_rcp_f32 v138, v138
  v_rcp_f32 v139, v139
  v_rcp_f32 v140, v140
  v_rcp_f32 v141, v141
  v_rcp_f32 v142, v142
  v_rcp_f32 v143, v143
  v_rcp_f32 v144, v144
  v_rcp_f32 v145, v145
  v_rcp_f32 v146, v146
  v_rcp_f32 v147, v147
  v_rcp_f32 v148, v148
  v_rcp_f32 v149, v149
  v_mul_f32 v118, v86, v118
  v_mul_f32 v119, v87, v119
  v_mul_f32 v120, v88, v120
  v_mul_f32 v121, v89, v121
  v_mul_f32 v122, v90, v122
  v_mul_f32 v123, v91, v123
  v_mul_f32 v124, v92, v124
  v_mul_f32 v125, v93, v125
  v_mul_f32 v126, v94, v126
  v_mul_f32 v127, v95, v127
  v_mul_f32 v128, v96, v128
  v_mul_f32 v129, v97, v129
  v_mul_f32 v130, v98, v130
  v_mul_f32 v131, v99, v131
  v_mul_f32 v132, v100, v132
  v_mul_f32 v133, v101, v133
  v_mul_f32 v134, v102, v134
  v_mul_f32 v135, v103, v135
  v_mul_f32 v136, v104, v136
  v_mul_f32 v137, v105, v137
  v_mul_f32 v138, v106, v138
  v_mul_f32 v139, v107, v139
  v_mul_f32 v140, v108, v140
  v_mul_f32 v141, v109, v141
  v_mul_f32 v142, v110, v142
  v_mul_f32 v143, v111, v143
  v_mul_f32 v144, v112, v144
  v_mul_f32 v145, v113, v145
  v_mul_f32 v146, v114, v146
  v_mul_f32 v147, v115, v147
  v_mul_f32 v148, v116, v148
  v_mul_f32 v149, v117, v149
  v_cvt_pk_bf16_f32 v150, v118, v119
  v_cvt_pk_bf16_f32 v151, v120, v121
  v_cvt_pk_bf16_f32 v152, v122, v123
  v_cvt_pk_bf16_f32 v153, v124, v125
  v_cvt_pk_bf16_f32 v154, v126, v127
  v_cvt_pk_bf16_f32 v155, v128, v129
  v_cvt_pk_bf16_f32 v156, v130, v131
  v_cvt_pk_bf16_f32 v157, v132, v133
  v_cvt_pk_bf16_f32 v158, v134, v135
  v_cvt_pk_bf16_f32 v159, v136, v137
  v_cvt_pk_bf16_f32 v160, v138, v139
  v_cvt_pk_bf16_f32 v161, v140, v141
  v_cvt_pk_bf16_f32 v162, v142, v143
  v_cvt_pk_bf16_f32 v163, v144, v145
  v_cvt_pk_bf16_f32 v164, v146, v147
  v_cvt_pk_bf16_f32 v165, v148, v149
  v_dot2_f32_bf16 v166, v150, v72, v166
  v_dot2_f32_bf16 v166, v151, v73, v166
  v_dot2_f32_bf16 v167, v152, v72, v167
  v_dot2_f32_bf16 v167, v153, v73, v167
  v_dot2_f32_bf16 v168, v154, v72, v168
  v_dot2_f32_bf16 v168, v155, v73, v168
  v_dot2_f32_bf16 v169, v156, v72, v169
  v_dot2_f32_bf16 v169, v157, v73, v169
  v_dot2_f32_bf16 v170, v158, v72, v170
  v_dot2_f32_bf16 v170, v159, v73, v170
  v_dot2_f32_bf16 v171, v160, v72, v171
  v_dot2_f32_bf16 v171, v161, v73, v171
  v_dot2_f32_bf16 v172, v162, v72, v172
  v_dot2_f32_bf16 v172, v163, v73, v172
  v_dot2_f32_bf16 v173, v164, v72, v173
  v_dot2_f32_bf16 v173, v165, v73, v173
  s_nop 2
  v_mul_f32 v86, v174, v20
  v_mul_f32 v87, v174, v21
  v_mul_f32 v88, v174, v22
  v_mul_f32 v89, v174, v23
  v_mul_f32 v90, v175, v20
  v_mul_f32 v91, v175, v21
  v_mul_f32 v92, v175, v22
  v_mul_f32 v93, v175, v23
  v_mul_f32 v94, v176, v20
  v_mul_f32 v95, v176, v21
  v_mul_f32 v96, v176, v22
  v_mul_f32 v97, v176, v23
  v_mul_f32 v98, v177, v20
  v_mul_f32 v99, v177, v21
  v_mul_f32 v100, v177, v22
  v_mul_f32 v101, v177, v23
  v_mul_f32 v102, v178, v20
  v_mul_f32 v103, v178, v21
  v_mul_f32 v104, v178, v22
  v_mul_f32 v105, v178, v23
  v_mul_f32 v106, v179, v20
  v_mul_f32 v107, v179, v21
  v_mul_f32 v108, v179, v22
  v_mul_f32 v109, v179, v23
  v_mul_f32 v110, v180, v20
  v_mul_f32 v111, v180, v21
  v_mul_f32 v112, v180, v22
  v_mul_f32 v113, v180, v23
  v_mul_f32 v114, v181, v20
  v_mul_f32 v115, v181, v21
  v_mul_f32 v116, v181, v22
  v_mul_f32 v117, v181, v23
  v_cvt_pk_bf16_f32 v150, v86, v87
  v_cvt_pk_bf16_f32 v151, v88, v89
  v_cvt_pk_bf16_f32 v152, v90, v91
  v_cvt_pk_bf16_f32 v153, v92, v93
  v_cvt_pk_bf16_f32 v154, v94, v95
  v_cvt_pk_bf16_f32 v155, v96, v97
  v_cvt_pk_bf16_f32 v156, v98, v99
  v_cvt_pk_bf16_f32 v157, v100, v101
  v_cvt_pk_bf16_f32 v158, v102, v103
  v_cvt_pk_bf16_f32 v159, v104, v105
  v_cvt_pk_bf16_f32 v160, v106, v107
  v_cvt_pk_bf16_f32 v161, v108, v109
  v_cvt_pk_bf16_f32 v162, v110, v111
  v_cvt_pk_bf16_f32 v163, v112, v113
  v_cvt_pk_bf16_f32 v164, v114, v115
  v_cvt_pk_bf16_f32 v165, v116, v117
  v_dot2_f32_bf16 v86, v150, s69, v48
  v_dot2_f32_bf16 v87, v150, s70, v49
  v_dot2_f32_bf16 v88, v151, s69, v50
  v_dot2_f32_bf16 v89, v151, s70, v51
  v_dot2_f32_bf16 v90, v152, s69, v48
  v_dot2_f32_bf16 v91, v152, s70, v49
  v_dot2_f32_bf16 v92, v153, s69, v50
  v_dot2_f32_bf16 v93, v153, s70, v51
  v_dot2_f32_bf16 v94, v154, s69, v48
  v_dot2_f32_bf16 v95, v154, s70, v49
  v_dot2_f32_bf16 v96, v155, s69, v50
  v_dot2_f32_bf16 v97, v155, s70, v51
  v_dot2_f32_bf16 v98, v156, s69, v48
  v_dot2_f32_bf16 v99, v156, s70, v49
  v_dot2_f32_bf16 v100, v157, s69, v50
  v_dot2_f32_bf16 v101, v157, s70, v51
  v_dot2_f32_bf16 v102, v158, s69, v48
  v_dot2_f32_bf16 v103, v158, s70, v49
  v_dot2_f32_bf16 v104, v159, s69, v50
  v_dot2_f32_bf16 v105, v159, s70, v51
  v_dot2_f32_bf16 v106, v160, s69, v48
  v_dot2_f32_bf16 v107, v160, s70, v49
  v_dot2_f32_bf16 v108, v161, s69, v50
  v_dot2_f32_bf16 v109, v161, s70, v51
  v_dot2_f32_bf16 v110, v162, s69, v48
  v_dot2_f32_bf16 v111, v162, s70, v49
  v_dot2_f32_bf16 v112, v163, s69, v50
  v_dot2_f32_bf16 v113, v163, s70, v51
  v_dot2_f32_bf16 v114, v164, s69, v48
  v_dot2_f32_bf16 v115, v164, s70, v49
  v_dot2_f32_bf16 v116, v165, s69, v50
  v_dot2_f32_bf16 v117, v165, s70, v51
  v_cvt_pk_bf16_f32 v150, v86, v87
  v_cvt_pk_bf16_f32 v151, v88, v89
  v_cvt_pk_bf16_f32 v152, v90, v91
  v_cvt_pk_bf16_f32 v153, v92, v93
  v_cvt_pk_bf16_f32 v154, v94, v95
  v_cvt_pk_bf16_f32 v155, v96, v97
  v_cvt_pk_bf16_f32 v156, v98, v99
  v_cvt_pk_bf16_f32 v157, v100, v101
  v_cvt_pk_bf16_f32 v158, v102, v103
  v_cvt_pk_bf16_f32 v159, v104, v105
  v_cvt_pk_bf16_f32 v160, v106, v107
  v_cvt_pk_bf16_f32 v161, v108, v109
  v_cvt_pk_bf16_f32 v162, v110, v111
  v_cvt_pk_bf16_f32 v163, v112, v113
  v_cvt_pk_bf16_f32 v164, v114, v115
  v_cvt_pk_bf16_f32 v165, v116, v117
  v_lshlrev_b32 v86, 16, v150
  v_and_b32 v87, 0xffff0000, v150
  v_lshlrev_b32 v88, 16, v151
  v_and_b32 v89, 0xffff0000, v151
  v_lshlrev_b32 v90, 16, v152
  v_and_b32 v91, 0xffff0000, v152
  v_lshlrev_b32 v92, 16, v153
  v_and_b32 v93, 0xffff0000, v153
  v_lshlrev_b32 v94, 16, v154
  v_and_b32 v95, 0xffff0000, v154
  v_lshlrev_b32 v96, 16, v155
  v_and_b32 v97, 0xffff0000, v155
  v_lshlrev_b32 v98, 16, v156
  v_and_b32 v99, 0xffff0000, v156
  v_lshlrev_b32 v100, 16, v157
  v_and_b32 v101, 0xffff0000, v157
  v_lshlrev_b32 v102, 16, v158
  v_and_b32 v103, 0xffff0000, v158
  v_lshlrev_b32 v104, 16, v159
  v_and_b32 v105, 0xffff0000, v159
  v_lshlrev_b32 v106, 16, v160
  v_and_b32 v107, 0xffff0000, v160
  v_lshlrev_b32 v108, 16, v161
  v_and_b32 v109, 0xffff0000, v161
  v_lshlrev_b32 v110, 16, v162
  v_and_b32 v111, 0xffff0000, v162
  v_lshlrev_b32 v112, 16, v163
  v_and_b32 v113, 0xffff0000, v163
  v_lshlrev_b32 v114, 16, v164
  v_and_b32 v115, 0xffff0000, v164
  v_lshlrev_b32 v116, 16, v165
  v_and_b32 v117, 0xffff0000, v165
  v_mul_f32 v118, v86, v86
  v_mul_f32 v119, v87, v87
  v_mul_f32 v120, v88, v88
  v_mul_f32 v121, v89, v89
  v_mul_f32 v122, v90, v90
  v_mul_f32 v123, v91, v91
  v_mul_f32 v124, v92, v92
  v_mul_f32 v125, v93, v93
  v_mul_f32 v126, v94, v94
  v_mul_f32 v127, v95, v95
  v_mul_f32 v128, v96, v96
  v_mul_f32 v129, v97, v97
  v_mul_f32 v130, v98, v98
  v_mul_f32 v131, v99, v99
  v_mul_f32 v132, v100, v100
  v_mul_f32 v133, v101, v101
  v_mul_f32 v134, v102, v102
  v_mul_f32 v135, v103, v103
  v_mul_f32 v136, v104, v104
  v_mul_f32 v137, v105, v105
  v_mul_f32 v138, v106, v106
  v_mul_f32 v139, v107, v107
  v_mul_f32 v140, v108, v108
  v_mul_f32 v141, v109, v109
  v_mul_f32 v142, v110, v110
  v_mul_f32 v143, v111, v111
  v_mul_f32 v144, v112, v112
  v_mul_f32 v145, v113, v113
  v_mul_f32 v146, v114, v114
  v_mul_f32 v147, v115, v115
  v_mul_f32 v148, v116, v116
  v_mul_f32 v149, v117, v117
  v_fmamk_f32 v118, v118, 0xbdd2d3e8, v182
  v_fmamk_f32 v119, v119, 0xbdd2d3e8, v182
  v_fmamk_f32 v120, v120, 0xbdd2d3e8, v182
  v_fmamk_f32 v121, v121, 0xbdd2d3e8, v182
  v_fmamk_f32 v122, v122, 0xbdd2d3e8, v182
  v_fmamk_f32 v123, v123, 0xbdd2d3e8, v182
  v_fmamk_f32 v124, v124, 0xbdd2d3e8, v182
  v_fmamk_f32 v125, v125, 0xbdd2d3e8, v182
  v_fmamk_f32 v126, v126, 0xbdd2d3e8, v182
  v_fmamk_f32 v127, v127, 0xbdd2d3e8, v182
  v_fmamk_f32 v128, v128, 0xbdd2d3e8, v182
  v_fmamk_f32 v129, v129, 0xbdd2d3e8, v182
  v_fmamk_f32 v130, v130, 0xbdd2d3e8, v182
  v_fmamk_f32 v131, v131, 0xbdd2d3e8, v182
  v_fmamk_f32 v132, v132, 0xbdd2d3e8, v182
  v_fmamk_f32 v133, v133, 0xbdd2d3e8, v182
  v_fmamk_f32 v134, v134, 0xbdd2d3e8, v182
  v_fmamk_f32 v135, v135, 0xbdd2d3e8, v182
  v_fmamk_f32 v136, v136, 0xbdd2d3e8, v182
  v_fmamk_f32 v137, v137, 0xbdd2d3e8, v182
  v_fmamk_f32 v138, v138, 0xbdd2d3e8, v182
  v_fmamk_f32 v139, v139, 0xbdd2d3e8, v182
  v_fmamk_f32 v140, v140, 0xbdd2d3e8, v182
  v_fmamk_f32 v141, v141, 0xbdd2d3e8, v182
  v_fmamk_f32 v142, v142, 0xbdd2d3e8, v182
  v_fmamk_f32 v143, v143, 0xbdd2d3e8, v182
  v_fmamk_f32 v144, v144, 0xbdd2d3e8, v182
  v_fmamk_f32 v145, v145, 0xbdd2d3e8, v182
  v_fmamk_f32 v146, v146, 0xbdd2d3e8, v182
  v_fmamk_f32 v147, v147, 0xbdd2d3e8, v182
  v_fmamk_f32 v148, v148, 0xbdd2d3e8, v182
  v_fmamk_f32 v149, v149, 0xbdd2d3e8, v182
  v_mul_f32 v118, v86, v118
  v_mul_f32 v119, v87, v119
  v_mul_f32 v120, v88, v120
  v_mul_f32 v121, v89, v121
  v_mul_f32 v122, v90, v122
  v_mul_f32 v123, v91, v123
  v_mul_f32 v124, v92, v124
  v_mul_f32 v125, v93, v125
  v_mul_f32 v126, v94, v126
  v_mul_f32 v127, v95, v127
  v_mul_f32 v128, v96, v128
  v_mul_f32 v129, v97, v129
  v_mul_f32 v130, v98, v130
  v_mul_f32 v131, v99, v131
  v_mul_f32 v132, v100, v132
  v_mul_f32 v133, v101, v133
  v_mul_f32 v134, v102, v134
  v_mul_f32 v135, v103, v135
  v_mul_f32 v136, v104, v136
  v_mul_f32 v137, v105, v137
  v_mul_f32 v138, v106, v138
  v_mul_f32 v139, v107, v139
  v_mul_f32 v140, v108, v140
  v_mul_f32 v141, v109, v141
  v_mul_f32 v142, v110, v142
  v_mul_f32 v143, v111, v143
  v_mul_f32 v144, v112, v144
  v_mul_f32 v145, v113, v145
  v_mul_f32 v146, v114, v146
  v_mul_f32 v147, v115, v147
  v_mul_f32 v148, v116, v148
  v_mul_f32 v149, v117, v149
  v_exp_f32 v118, v118
  v_exp_f32 v119, v119
  v_exp_f32 v120, v120
  v_exp_f32 v121, v121
  v_exp_f32 v122, v122
  v_exp_f32 v123, v123
  v_exp_f32 v124, v124
  v_exp_f32 v125, v125
  v_exp_f32 v126, v126
  v_exp_f32 v127, v127
  v_exp_f32 v128, v128
  v_exp_f32 v129, v129
  v_exp_f32 v130, v130
  v_exp_f32 v131, v131
  v_exp_f32 v132, v132
  v_exp_f32 v133, v133
  v_exp_f32 v134, v134
  v_exp_f32 v135, v135
  v_exp_f32 v136, v136
  v_exp_f32 v137, v137
  v_exp_f32 v138, v138
  v_exp_f32 v139, v139
  v_exp_f32 v140, v140
  v_exp_f32 v141, v141
  v_exp_f32 v142, v142
  v_exp_f32 v143, v143
  v_exp_f32 v144, v144
  v_exp_f32 v145, v145
  v_exp_f32 v146, v146
  v_exp_f32 v147, v147
  v_exp_f32 v148, v148
  v_exp_f32 v149, v149
  v_add_f32 v118, 1.0, v118
  v_add_f32 v119, 1.0, v119
  v_add_f32 v120, 1.0, v120
  v_add_f32 v121, 1.0, v121
  v_add_f32 v122, 1.0, v122
  v_add_f32 v123, 1.0, v123
  v_add_f32 v124, 1.0, v124
  v_add_f32 v125, 1.0, v125
  v_add_f32 v126, 1.0, v126
  v_add_f32 v127, 1.0, v127
  v_add_f32 v128, 1.0, v128
  v_add_f32 v129, 1.0, v129
  v_add_f32 v130, 1.0, v130
  v_add_f32 v131, 1.0, v131
  v_add_f32 v132, 1.0, v132
  v_add_f32 v133, 1.0, v133
  v_add_f32 v134, 1.0, v134
  v_add_f32 v135, 1.0, v135
  v_add_f32 v136, 1.0, v136
  v_add_f32 v137, 1.0, v137
  v_add_f32 v138, 1.0, v138
  v_add_f32 v139, 1.0, v139
  v_add_f32 v140, 1.0, v140
  v_add_f32 v141, 1.0, v141
  v_add_f32 v142, 1.0, v142
  v_add_f32 v143, 1.0, v143
  v_add_f32 v144, 1.0, v144
  v_add_f32 v145, 1.0, v145
  v_add_f32 v146, 1.0, v146
  v_add_f32 v147, 1.0, v147
  v_add_f32 v148, 1.0, v148
  v_add_f32 v149, 1.0, v149
  v_rcp_f32 v118, v118
  v_rcp_f32 v119, v119
  v_rcp_f32 v120, v120
  v_rcp_f32 v121, v121
  v_rcp_f32 v122, v122
  v_rcp_f32 v123, v123
  v_rcp_f32 v124, v124
  v_rcp_f32 v125, v125
  v_rcp_f32 v126, v126
  v_rcp_f32 v127, v127
  v_rcp_f32 v128, v128
  v_rcp_f32 v129, v129
  v_rcp_f32 v130, v130
  v_rcp_f32 v131, v131
  v_rcp_f32 v132, v132
  v_rcp_f32 v133, v133
  v_rcp_f32 v134, v134
  v_rcp_f32 v135, v135
  v_rcp_f32 v136, v136
  v_rcp_f32 v137, v137
  v_rcp_f32 v138, v138
  v_rcp_f32 v139, v139
  v_rcp_f32 v140, v140
  v_rcp_f32 v141, v141
  v_rcp_f32 v142, v142
  v_rcp_f32 v143, v143
  v_rcp_f32 v144, v144
  v_rcp_f32 v145, v145
  v_rcp_f32 v146, v146
  v_rcp_f32 v147, v147
  v_rcp_f32 v148, v148
  v_rcp_f32 v149, v149
  v_mul_f32 v118, v86, v118
  v_mul_f32 v119, v87, v119
  v_mul_f32 v120, v88, v120
  v_mul_f32 v121, v89, v121
  v_mul_f32 v122, v90, v122
  v_mul_f32 v123, v91, v123
  v_mul_f32 v124, v92, v124
  v_mul_f32 v125, v93, v125
  v_mul_f32 v126, v94, v126
  v_mul_f32 v127, v95, v127
  v_mul_f32 v128, v96, v128
  v_mul_f32 v129, v97, v129
  v_mul_f32 v130, v98, v130
  v_mul_f32 v131, v99, v131
  v_mul_f32 v132, v100, v132
  v_mul_f32 v133, v101, v133
  v_mul_f32 v134, v102, v134
  v_mul_f32 v135, v103, v135
  v_mul_f32 v136, v104, v136
  v_mul_f32 v137, v105, v137
  v_mul_f32 v138, v106, v138
  v_mul_f32 v139, v107, v139
  v_mul_f32 v140, v108, v140
  v_mul_f32 v141, v109, v141
  v_mul_f32 v142, v110, v142
  v_mul_f32 v143, v111, v143
  v_mul_f32 v144, v112, v144
  v_mul_f32 v145, v113, v145
  v_mul_f32 v146, v114, v146
  v_mul_f32 v147, v115, v147
  v_mul_f32 v148, v116, v148
  v_mul_f32 v149, v117, v149
  v_cvt_pk_bf16_f32 v150, v118, v119
  v_cvt_pk_bf16_f32 v151, v120, v121
  v_cvt_pk_bf16_f32 v152, v122, v123
  v_cvt_pk_bf16_f32 v153, v124, v125
  v_cvt_pk_bf16_f32 v154, v126, v127
  v_cvt_pk_bf16_f32 v155, v128, v129
  v_cvt_pk_bf16_f32 v156, v130, v131
  v_cvt_pk_bf16_f32 v157, v132, v133
  v_cvt_pk_bf16_f32 v158, v134, v135
  v_cvt_pk_bf16_f32 v159, v136, v137
  v_cvt_pk_bf16_f32 v160, v138, v139
  v_cvt_pk_bf16_f32 v161, v140, v141
  v_cvt_pk_bf16_f32 v162, v142, v143
  v_cvt_pk_bf16_f32 v163, v144, v145
  v_cvt_pk_bf16_f32 v164, v146, v147
  v_cvt_pk_bf16_f32 v165, v148, v149
  v_dot2_f32_bf16 v166, v150, v74, v166
  v_dot2_f32_bf16 v166, v151, v75, v166
  v_dot2_f32_bf16 v167, v152, v74, v167
  v_dot2_f32_bf16 v167, v153, v75, v167
  v_dot2_f32_bf16 v168, v154, v74, v168
  v_dot2_f32_bf16 v168, v155, v75, v168
  v_dot2_f32_bf16 v169, v156, v74, v169
  v_dot2_f32_bf16 v169, v157, v75, v169
  v_dot2_f32_bf16 v170, v158, v74, v170
  v_dot2_f32_bf16 v170, v159, v75, v170
  v_dot2_f32_bf16 v171, v160, v74, v171
  v_dot2_f32_bf16 v171, v161, v75, v171
  v_dot2_f32_bf16 v172, v162, v74, v172
  v_dot2_f32_bf16 v172, v163, v75, v172
  v_dot2_f32_bf16 v173, v164, v74, v173
  v_dot2_f32_bf16 v173, v165, v75, v173
  s_nop 2
  v_mul_f32 v86, v174, v24
  v_mul_f32 v87, v174, v25
  v_mul_f32 v88, v174, v26
  v_mul_f32 v89, v174, v27
  v_mul_f32 v90, v175, v24
  v_mul_f32 v91, v175, v25
  v_mul_f32 v92, v175, v26
  v_mul_f32 v93, v175, v27
  v_mul_f32 v94, v176, v24
  v_mul_f32 v95, v176, v25
  v_mul_f32 v96, v176, v26
  v_mul_f32 v97, v176, v27
  v_mul_f32 v98, v177, v24
  v_mul_f32 v99, v177, v25
  v_mul_f32 v100, v177, v26
  v_mul_f32 v101, v177, v27
  v_mul_f32 v102, v178, v24
  v_mul_f32 v103, v178, v25
  v_mul_f32 v104, v178, v26
  v_mul_f32 v105, v178, v27
  v_mul_f32 v106, v179, v24
  v_mul_f32 v107, v179, v25
  v_mul_f32 v108, v179, v26
  v_mul_f32 v109, v179, v27
  v_mul_f32 v110, v180, v24
  v_mul_f32 v111, v180, v25
  v_mul_f32 v112, v180, v26
  v_mul_f32 v113, v180, v27
  v_mul_f32 v114, v181, v24
  v_mul_f32 v115, v181, v25
  v_mul_f32 v116, v181, v26
  v_mul_f32 v117, v181, v27
  v_cvt_pk_bf16_f32 v150, v86, v87
  v_cvt_pk_bf16_f32 v151, v88, v89
  v_cvt_pk_bf16_f32 v152, v90, v91
  v_cvt_pk_bf16_f32 v153, v92, v93
  v_cvt_pk_bf16_f32 v154, v94, v95
  v_cvt_pk_bf16_f32 v155, v96, v97
  v_cvt_pk_bf16_f32 v156, v98, v99
  v_cvt_pk_bf16_f32 v157, v100, v101
  v_cvt_pk_bf16_f32 v158, v102, v103
  v_cvt_pk_bf16_f32 v159, v104, v105
  v_cvt_pk_bf16_f32 v160, v106, v107
  v_cvt_pk_bf16_f32 v161, v108, v109
  v_cvt_pk_bf16_f32 v162, v110, v111
  v_cvt_pk_bf16_f32 v163, v112, v113
  v_cvt_pk_bf16_f32 v164, v114, v115
  v_cvt_pk_bf16_f32 v165, v116, v117
  v_dot2_f32_bf16 v86, v150, s69, v52
  v_dot2_f32_bf16 v87, v150, s70, v53
  v_dot2_f32_bf16 v88, v151, s69, v54
  v_dot2_f32_bf16 v89, v151, s70, v55
  v_dot2_f32_bf16 v90, v152, s69, v52
  v_dot2_f32_bf16 v91, v152, s70, v53
  v_dot2_f32_bf16 v92, v153, s69, v54
  v_dot2_f32_bf16 v93, v153, s70, v55
  v_dot2_f32_bf16 v94, v154, s69, v52
  v_dot2_f32_bf16 v95, v154, s70, v53
  v_dot2_f32_bf16 v96, v155, s69, v54
  v_dot2_f32_bf16 v97, v155, s70, v55
  v_dot2_f32_bf16 v98, v156, s69, v52
  v_dot2_f32_bf16 v99, v156, s70, v53
  v_dot2_f32_bf16 v100, v157, s69, v54
  v_dot2_f32_bf16 v101, v157, s70, v55
  v_dot2_f32_bf16 v102, v158, s69, v52
  v_dot2_f32_bf16 v103, v158, s70, v53
  v_dot2_f32_bf16 v104, v159, s69, v54
  v_dot2_f32_bf16 v105, v159, s70, v55
  v_dot2_f32_bf16 v106, v160, s69, v52
  v_dot2_f32_bf16 v107, v160, s70, v53
  v_dot2_f32_bf16 v108, v161, s69, v54
  v_dot2_f32_bf16 v109, v161, s70, v55
  v_dot2_f32_bf16 v110, v162, s69, v52
  v_dot2_f32_bf16 v111, v162, s70, v53
  v_dot2_f32_bf16 v112, v163, s69, v54
  v_dot2_f32_bf16 v113, v163, s70, v55
  v_dot2_f32_bf16 v114, v164, s69, v52
  v_dot2_f32_bf16 v115, v164, s70, v53
  v_dot2_f32_bf16 v116, v165, s69, v54
  v_dot2_f32_bf16 v117, v165, s70, v55
  v_cvt_pk_bf16_f32 v150, v86, v87
  v_cvt_pk_bf16_f32 v151, v88, v89
  v_cvt_pk_bf16_f32 v152, v90, v91
  v_cvt_pk_bf16_f32 v153, v92, v93
  v_cvt_pk_bf16_f32 v154, v94, v95
  v_cvt_pk_bf16_f32 v155, v96, v97
  v_cvt_pk_bf16_f32 v156, v98, v99
  v_cvt_pk_bf16_f32 v157, v100, v101
  v_cvt_pk_bf16_f32 v158, v102, v103
  v_cvt_pk_bf16_f32 v159, v104, v105
  v_cvt_pk_bf16_f32 v160, v106, v107
  v_cvt_pk_bf16_f32 v161, v108, v109
  v_cvt_pk_bf16_f32 v162, v110, v111
  v_cvt_pk_bf16_f32 v163, v112, v113
  v_cvt_pk_bf16_f32 v164, v114, v115
  v_cvt_pk_bf16_f32 v165, v116, v117
  v_lshlrev_b32 v86, 16, v150
  v_and_b32 v87, 0xffff0000, v150
  v_lshlrev_b32 v88, 16, v151
  v_and_b32 v89, 0xffff0000, v151
  v_lshlrev_b32 v90, 16, v152
  v_and_b32 v91, 0xffff0000, v152
  v_lshlrev_b32 v92, 16, v153
  v_and_b32 v93, 0xffff0000, v153
  v_lshlrev_b32 v94, 16, v154
  v_and_b32 v95, 0xffff0000, v154
  v_lshlrev_b32 v96, 16, v155
  v_and_b32 v97, 0xffff0000, v155
  v_lshlrev_b32 v98, 16, v156
  v_and_b32 v99, 0xffff0000, v156
  v_lshlrev_b32 v100, 16, v157
  v_and_b32 v101, 0xffff0000, v157
  v_lshlrev_b32 v102, 16, v158
  v_and_b32 v103, 0xffff0000, v158
  v_lshlrev_b32 v104, 16, v159
  v_and_b32 v105, 0xffff0000, v159
  v_lshlrev_b32 v106, 16, v160
  v_and_b32 v107, 0xffff0000, v160
  v_lshlrev_b32 v108, 16, v161
  v_and_b32 v109, 0xffff0000, v161
  v_lshlrev_b32 v110, 16, v162
  v_and_b32 v111, 0xffff0000, v162
  v_lshlrev_b32 v112, 16, v163
  v_and_b32 v113, 0xffff0000, v163
  v_lshlrev_b32 v114, 16, v164
  v_and_b32 v115, 0xffff0000, v164
  v_lshlrev_b32 v116, 16, v165
  v_and_b32 v117, 0xffff0000, v165
  v_mul_f32 v118, v86, v86
  v_mul_f32 v119, v87, v87
  v_mul_f32 v120, v88, v88
  v_mul_f32 v121, v89, v89
  v_mul_f32 v122, v90, v90
  v_mul_f32 v123, v91, v91
  v_mul_f32 v124, v92, v92
  v_mul_f32 v125, v93, v93
  v_mul_f32 v126, v94, v94
  v_mul_f32 v127, v95, v95
  v_mul_f32 v128, v96, v96
  v_mul_f32 v129, v97, v97
  v_mul_f32 v130, v98, v98
  v_mul_f32 v131, v99, v99
  v_mul_f32 v132, v100, v100
  v_mul_f32 v133, v101, v101
  v_mul_f32 v134, v102, v102
  v_mul_f32 v135, v103, v103
  v_mul_f32 v136, v104, v104
  v_mul_f32 v137, v105, v105
  v_mul_f32 v138, v106, v106
  v_mul_f32 v139, v107, v107
  v_mul_f32 v140, v108, v108
  v_mul_f32 v141, v109, v109
  v_mul_f32 v142, v110, v110
  v_mul_f32 v143, v111, v111
  v_mul_f32 v144, v112, v112
  v_mul_f32 v145, v113, v113
  v_mul_f32 v146, v114, v114
  v_mul_f32 v147, v115, v115
  v_mul_f32 v148, v116, v116
  v_mul_f32 v149, v117, v117
  v_fmamk_f32 v118, v118, 0xbdd2d3e8, v182
  v_fmamk_f32 v119, v119, 0xbdd2d3e8, v182
  v_fmamk_f32 v120, v120, 0xbdd2d3e8, v182
  v_fmamk_f32 v121, v121, 0xbdd2d3e8, v182
  v_fmamk_f32 v122, v122, 0xbdd2d3e8, v182
  v_fmamk_f32 v123, v123, 0xbdd2d3e8, v182
  v_fmamk_f32 v124, v124, 0xbdd2d3e8, v182
  v_fmamk_f32 v125, v125, 0xbdd2d3e8, v182
  v_fmamk_f32 v126, v126, 0xbdd2d3e8, v182
  v_fmamk_f32 v127, v127, 0xbdd2d3e8, v182
  v_fmamk_f32 v128, v128, 0xbdd2d3e8, v182
  v_fmamk_f32 v129, v129, 0xbdd2d3e8, v182
  v_fmamk_f32 v130, v130, 0xbdd2d3e8, v182
  v_fmamk_f32 v131, v131, 0xbdd2d3e8, v182
  v_fmamk_f32 v132, v132, 0xbdd2d3e8, v182
  v_fmamk_f32 v133, v133, 0xbdd2d3e8, v182
  v_fmamk_f32 v134, v134, 0xbdd2d3e8, v182
  v_fmamk_f32 v135, v135, 0xbdd2d3e8, v182
  v_fmamk_f32 v136, v136, 0xbdd2d3e8, v182
  v_fmamk_f32 v137, v137, 0xbdd2d3e8, v182
  v_fmamk_f32 v138, v138, 0xbdd2d3e8, v182
  v_fmamk_f32 v139, v139, 0xbdd2d3e8, v182
  v_fmamk_f32 v140, v140, 0xbdd2d3e8, v182
  v_fmamk_f32 v141, v141, 0xbdd2d3e8, v182
  v_fmamk_f32 v142, v142, 0xbdd2d3e8, v182
  v_fmamk_f32 v143, v143, 0xbdd2d3e8, v182
  v_fmamk_f32 v144, v144, 0xbdd2d3e8, v182
  v_fmamk_f32 v145, v145, 0xbdd2d3e8, v182
  v_fmamk_f32 v146, v146, 0xbdd2d3e8, v182
  v_fmamk_f32 v147, v147, 0xbdd2d3e8, v182
  v_fmamk_f32 v148, v148, 0xbdd2d3e8, v182
  v_fmamk_f32 v149, v149, 0xbdd2d3e8, v182
  v_mul_f32 v118, v86, v118
  v_mul_f32 v119, v87, v119
  v_mul_f32 v120, v88, v120
  v_mul_f32 v121, v89, v121
  v_mul_f32 v122, v90, v122
  v_mul_f32 v123, v91, v123
  v_mul_f32 v124, v92, v124
  v_mul_f32 v125, v93, v125
  v_mul_f32 v126, v94, v126
  v_mul_f32 v127, v95, v127
  v_mul_f32 v128, v96, v128
  v_mul_f32 v129, v97, v129
  v_mul_f32 v130, v98, v130
  v_mul_f32 v131, v99, v131
  v_mul_f32 v132, v100, v132
  v_mul_f32 v133, v101, v133
  v_mul_f32 v134, v102, v134
  v_mul_f32 v135, v103, v135
  v_mul_f32 v136, v104, v136
  v_mul_f32 v137, v105, v137
  v_mul_f32 v138, v106, v138
  v_mul_f32 v139, v107, v139
  v_mul_f32 v140, v108, v140
  v_mul_f32 v141, v109, v141
  v_mul_f32 v142, v110, v142
  v_mul_f32 v143, v111, v143
  v_mul_f32 v144, v112, v144
  v_mul_f32 v145, v113, v145
  v_mul_f32 v146, v114, v146
  v_mul_f32 v147, v115, v147
  v_mul_f32 v148, v116, v148
  v_mul_f32 v149, v117, v149
  v_exp_f32 v118, v118
  v_exp_f32 v119, v119
  v_exp_f32 v120, v120
  v_exp_f32 v121, v121
  v_exp_f32 v122, v122
  v_exp_f32 v123, v123
  v_exp_f32 v124, v124
  v_exp_f32 v125, v125
  v_exp_f32 v126, v126
  v_exp_f32 v127, v127
  v_exp_f32 v128, v128
  v_exp_f32 v129, v129
  v_exp_f32 v130, v130
  v_exp_f32 v131, v131
  v_exp_f32 v132, v132
  v_exp_f32 v133, v133
  v_exp_f32 v134, v134
  v_exp_f32 v135, v135
  v_exp_f32 v136, v136
  v_exp_f32 v137, v137
  v_exp_f32 v138, v138
  v_exp_f32 v139, v139
  v_exp_f32 v140, v140
  v_exp_f32 v141, v141
  v_exp_f32 v142, v142
  v_exp_f32 v143, v143
  v_exp_f32 v144, v144
  v_exp_f32 v145, v145
  v_exp_f32 v146, v146
  v_exp_f32 v147, v147
  v_exp_f32 v148, v148
  v_exp_f32 v149, v149
  v_add_f32 v118, 1.0, v118
  v_add_f32 v119, 1.0, v119
  v_add_f32 v120, 1.0, v120
  v_add_f32 v121, 1.0, v121
  v_add_f32 v122, 1.0, v122
  v_add_f32 v123, 1.0, v123
  v_add_f32 v124, 1.0, v124
  v_add_f32 v125, 1.0, v125
  v_add_f32 v126, 1.0, v126
  v_add_f32 v127, 1.0, v127
  v_add_f32 v128, 1.0, v128
  v_add_f32 v129, 1.0, v129
  v_add_f32 v130, 1.0, v130
  v_add_f32 v131, 1.0, v131
  v_add_f32 v132, 1.0, v132
  v_add_f32 v133, 1.0, v133
  v_add_f32 v134, 1.0, v134
  v_add_f32 v135, 1.0, v135
  v_add_f32 v136, 1.0, v136
  v_add_f32 v137, 1.0, v137
  v_add_f32 v138, 1.0, v138
  v_add_f32 v139, 1.0, v139
  v_add_f32 v140, 1.0, v140
  v_add_f32 v141, 1.0, v141
  v_add_f32 v142, 1.0, v142
  v_add_f32 v143, 1.0, v143
  v_add_f32 v144, 1.0, v144
  v_add_f32 v145, 1.0, v145
  v_add_f32 v146, 1.0, v146
  v_add_f32 v147, 1.0, v147
  v_add_f32 v148, 1.0, v148
  v_add_f32 v149, 1.0, v149
  v_rcp_f32 v118, v118
  v_rcp_f32 v119, v119
  v_rcp_f32 v120, v120
  v_rcp_f32 v121, v121
  v_rcp_f32 v122, v122
  v_rcp_f32 v123, v123
  v_rcp_f32 v124, v124
  v_rcp_f32 v125, v125
  v_rcp_f32 v126, v126
  v_rcp_f32 v127, v127
  v_rcp_f32 v128, v128
  v_rcp_f32 v129, v129
  v_rcp_f32 v130, v130
  v_rcp_f32 v131, v131
  v_rcp_f32 v132, v132
  v_rcp_f32 v133, v133
  v_rcp_f32 v134, v134
  v_rcp_f32 v135, v135
  v_rcp_f32 v136, v136
  v_rcp_f32 v137, v137
  v_rcp_f32 v138, v138
  v_rcp_f32 v139, v139
  v_rcp_f32 v140, v140
  v_rcp_f32 v141, v141
  v_rcp_f32 v142, v142
  v_rcp_f32 v143, v143
  v_rcp_f32 v144, v144
  v_rcp_f32 v145, v145
  v_rcp_f32 v146, v146
  v_rcp_f32 v147, v147
  v_rcp_f32 v148, v148
  v_rcp_f32 v149, v149
  v_mul_f32 v118, v86, v118
  v_mul_f32 v119, v87, v119
  v_mul_f32 v120, v88, v120
  v_mul_f32 v121, v89, v121
  v_mul_f32 v122, v90, v122
  v_mul_f32 v123, v91, v123
  v_mul_f32 v124, v92, v124
  v_mul_f32 v125, v93, v125
  v_mul_f32 v126, v94, v126
  v_mul_f32 v127, v95, v127
  v_mul_f32 v128, v96, v128
  v_mul_f32 v129, v97, v129
  v_mul_f32 v130, v98, v130
  v_mul_f32 v131, v99, v131
  v_mul_f32 v132, v100, v132
  v_mul_f32 v133, v101, v133
  v_mul_f32 v134, v102, v134
  v_mul_f32 v135, v103, v135
  v_mul_f32 v136, v104, v136
  v_mul_f32 v137, v105, v137
  v_mul_f32 v138, v106, v138
  v_mul_f32 v139, v107, v139
  v_mul_f32 v140, v108, v140
  v_mul_f32 v141, v109, v141
  v_mul_f32 v142, v110, v142
  v_mul_f32 v143, v111, v143
  v_mul_f32 v144, v112, v144
  v_mul_f32 v145, v113, v145
  v_mul_f32 v146, v114, v146
  v_mul_f32 v147, v115, v147
  v_mul_f32 v148, v116, v148
  v_mul_f32 v149, v117, v149
  v_cvt_pk_bf16_f32 v150, v118, v119
  v_cvt_pk_bf16_f32 v151, v120, v121
  v_cvt_pk_bf16_f32 v152, v122, v123
  v_cvt_pk_bf16_f32 v153, v124, v125
  v_cvt_pk_bf16_f32 v154, v126, v127
  v_cvt_pk_bf16_f32 v155, v128, v129
  v_cvt_pk_bf16_f32 v156, v130, v131
  v_cvt_pk_bf16_f32 v157, v132, v133
  v_cvt_pk_bf16_f32 v158, v134, v135
  v_cvt_pk_bf16_f32 v159, v136, v137
  v_cvt_pk_bf16_f32 v160, v138, v139
  v_cvt_pk_bf16_f32 v161, v140, v141
  v_cvt_pk_bf16_f32 v162, v142, v143
  v_cvt_pk_bf16_f32 v163, v144, v145
  v_cvt_pk_bf16_f32 v164, v146, v147
  v_cvt_pk_bf16_f32 v165, v148, v149
  v_dot2_f32_bf16 v166, v150, v76, v166
  v_dot2_f32_bf16 v166, v151, v77, v166
  v_dot2_f32_bf16 v167, v152, v76, v167
  v_dot2_f32_bf16 v167, v153, v77, v167
  v_dot2_f32_bf16 v168, v154, v76, v168
  v_dot2_f32_bf16 v168, v155, v77, v168
  v_dot2_f32_bf16 v169, v156, v76, v169
  v_dot2_f32_bf16 v169, v157, v77, v169
  v_dot2_f32_bf16 v170, v158, v76, v170
  v_dot2_f32_bf16 v170, v159, v77, v170
  v_dot2_f32_bf16 v171, v160, v76, v171
  v_dot2_f32_bf16 v171, v161, v77, v171
  v_dot2_f32_bf16 v172, v162, v76, v172
  v_dot2_f32_bf16 v172, v163, v77, v172
  v_dot2_f32_bf16 v173, v164, v76, v173
  v_dot2_f32_bf16 v173, v165, v77, v173
  s_nop 2
  v_mul_f32 v86, v174, v28
  v_mul_f32 v87, v174, v29
  v_mul_f32 v88, v174, v30
  v_mul_f32 v89, v174, v31
  v_mul_f32 v90, v175, v28
  v_mul_f32 v91, v175, v29
  v_mul_f32 v92, v175, v30
  v_mul_f32 v93, v175, v31
  v_mul_f32 v94, v176, v28
  v_mul_f32 v95, v176, v29
  v_mul_f32 v96, v176, v30
  v_mul_f32 v97, v176, v31
  v_mul_f32 v98, v177, v28
  v_mul_f32 v99, v177, v29
  v_mul_f32 v100, v177, v30
  v_mul_f32 v101, v177, v31
  v_mul_f32 v102, v178, v28
  v_mul_f32 v103, v178, v29
  v_mul_f32 v104, v178, v30
  v_mul_f32 v105, v178, v31
  v_mul_f32 v106, v179, v28
  v_mul_f32 v107, v179, v29
  v_mul_f32 v108, v179, v30
  v_mul_f32 v109, v179, v31
  v_mul_f32 v110, v180, v28
  v_mul_f32 v111, v180, v29
  v_mul_f32 v112, v180, v30
  v_mul_f32 v113, v180, v31
  v_mul_f32 v114, v181, v28
  v_mul_f32 v115, v181, v29
  v_mul_f32 v116, v181, v30
  v_mul_f32 v117, v181, v31
  v_cvt_pk_bf16_f32 v150, v86, v87
  v_cvt_pk_bf16_f32 v151, v88, v89
  v_cvt_pk_bf16_f32 v152, v90, v91
  v_cvt_pk_bf16_f32 v153, v92, v93
  v_cvt_pk_bf16_f32 v154, v94, v95
  v_cvt_pk_bf16_f32 v155, v96, v97
  v_cvt_pk_bf16_f32 v156, v98, v99
  v_cvt_pk_bf16_f32 v157, v100, v101
  v_cvt_pk_bf16_f32 v158, v102, v103
  v_cvt_pk_bf16_f32 v159, v104, v105
  v_cvt_pk_bf16_f32 v160, v106, v107
  v_cvt_pk_bf16_f32 v161, v108, v109
  v_cvt_pk_bf16_f32 v162, v110, v111
  v_cvt_pk_bf16_f32 v163, v112, v113
  v_cvt_pk_bf16_f32 v164, v114, v115
  v_cvt_pk_bf16_f32 v165, v116, v117
  v_dot2_f32_bf16 v86, v150, s69, v56
  v_dot2_f32_bf16 v87, v150, s70, v57
  v_dot2_f32_bf16 v88, v151, s69, v58
  v_dot2_f32_bf16 v89, v151, s70, v59
  v_dot2_f32_bf16 v90, v152, s69, v56
  v_dot2_f32_bf16 v91, v152, s70, v57
  v_dot2_f32_bf16 v92, v153, s69, v58
  v_dot2_f32_bf16 v93, v153, s70, v59
  v_dot2_f32_bf16 v94, v154, s69, v56
  v_dot2_f32_bf16 v95, v154, s70, v57
  v_dot2_f32_bf16 v96, v155, s69, v58
  v_dot2_f32_bf16 v97, v155, s70, v59
  v_dot2_f32_bf16 v98, v156, s69, v56
  v_dot2_f32_bf16 v99, v156, s70, v57
  v_dot2_f32_bf16 v100, v157, s69, v58
  v_dot2_f32_bf16 v101, v157, s70, v59
  v_dot2_f32_bf16 v102, v158, s69, v56
  v_dot2_f32_bf16 v103, v158, s70, v57
  v_dot2_f32_bf16 v104, v159, s69, v58
  v_dot2_f32_bf16 v105, v159, s70, v59
  v_dot2_f32_bf16 v106, v160, s69, v56
  v_dot2_f32_bf16 v107, v160, s70, v57
  v_dot2_f32_bf16 v108, v161, s69, v58
  v_dot2_f32_bf16 v109, v161, s70, v59
  v_dot2_f32_bf16 v110, v162, s69, v56
  v_dot2_f32_bf16 v111, v162, s70, v57
  v_dot2_f32_bf16 v112, v163, s69, v58
  v_dot2_f32_bf16 v113, v163, s70, v59
  v_dot2_f32_bf16 v114, v164, s69, v56
  v_dot2_f32_bf16 v115, v164, s70, v57
  v_dot2_f32_bf16 v116, v165, s69, v58
  v_dot2_f32_bf16 v117, v165, s70, v59
  v_cvt_pk_bf16_f32 v150, v86, v87
  v_cvt_pk_bf16_f32 v151, v88, v89
  v_cvt_pk_bf16_f32 v152, v90, v91
  v_cvt_pk_bf16_f32 v153, v92, v93
  v_cvt_pk_bf16_f32 v154, v94, v95
  v_cvt_pk_bf16_f32 v155, v96, v97
  v_cvt_pk_bf16_f32 v156, v98, v99
  v_cvt_pk_bf16_f32 v157, v100, v101
  v_cvt_pk_bf16_f32 v158, v102, v103
  v_cvt_pk_bf16_f32 v159, v104, v105
  v_cvt_pk_bf16_f32 v160, v106, v107
  v_cvt_pk_bf16_f32 v161, v108, v109
  v_cvt_pk_bf16_f32 v162, v110, v111
  v_cvt_pk_bf16_f32 v163, v112, v113
  v_cvt_pk_bf16_f32 v164, v114, v115
  v_cvt_pk_bf16_f32 v165, v116, v117
  v_lshlrev_b32 v86, 16, v150
  v_and_b32 v87, 0xffff0000, v150
  v_lshlrev_b32 v88, 16, v151
  v_and_b32 v89, 0xffff0000, v151
  v_lshlrev_b32 v90, 16, v152
  v_and_b32 v91, 0xffff0000, v152
  v_lshlrev_b32 v92, 16, v153
  v_and_b32 v93, 0xffff0000, v153
  v_lshlrev_b32 v94, 16, v154
  v_and_b32 v95, 0xffff0000, v154
  v_lshlrev_b32 v96, 16, v155
  v_and_b32 v97, 0xffff0000, v155
  v_lshlrev_b32 v98, 16, v156
  v_and_b32 v99, 0xffff0000, v156
  v_lshlrev_b32 v100, 16, v157
  v_and_b32 v101, 0xffff0000, v157
  v_lshlrev_b32 v102, 16, v158
  v_and_b32 v103, 0xffff0000, v158
  v_lshlrev_b32 v104, 16, v159
  v_and_b32 v105, 0xffff0000, v159
  v_lshlrev_b32 v106, 16, v160
  v_and_b32 v107, 0xffff0000, v160
  v_lshlrev_b32 v108, 16, v161
  v_and_b32 v109, 0xffff0000, v161
  v_lshlrev_b32 v110, 16, v162
  v_and_b32 v111, 0xffff0000, v162
  v_lshlrev_b32 v112, 16, v163
  v_and_b32 v113, 0xffff0000, v163
  v_lshlrev_b32 v114, 16, v164
  v_and_b32 v115, 0xffff0000, v164
  v_lshlrev_b32 v116, 16, v165
  v_and_b32 v117, 0xffff0000, v165
  v_mul_f32 v118, v86, v86
  v_mul_f32 v119, v87, v87
  v_mul_f32 v120, v88, v88
  v_mul_f32 v121, v89, v89
  v_mul_f32 v122, v90, v90
  v_mul_f32 v123, v91, v91
  v_mul_f32 v124, v92, v92
  v_mul_f32 v125, v93, v93
  v_mul_f32 v126, v94, v94
  v_mul_f32 v127, v95, v95
  v_mul_f32 v128, v96, v96
  v_mul_f32 v129, v97, v97
  v_mul_f32 v130, v98, v98
  v_mul_f32 v131, v99, v99
  v_mul_f32 v132, v100, v100
  v_mul_f32 v133, v101, v101
  v_mul_f32 v134, v102, v102
  v_mul_f32 v135, v103, v103
  v_mul_f32 v136, v104, v104
  v_mul_f32 v137, v105, v105
  v_mul_f32 v138, v106, v106
  v_mul_f32 v139, v107, v107
  v_mul_f32 v140, v108, v108
  v_mul_f32 v141, v109, v109
  v_mul_f32 v142, v110, v110
  v_mul_f32 v143, v111, v111
  v_mul_f32 v144, v112, v112
  v_mul_f32 v145, v113, v113
  v_mul_f32 v146, v114, v114
  v_mul_f32 v147, v115, v115
  v_mul_f32 v148, v116, v116
  v_mul_f32 v149, v117, v117
  v_fmamk_f32 v118, v118, 0xbdd2d3e8, v182
  v_fmamk_f32 v119, v119, 0xbdd2d3e8, v182
  v_fmamk_f32 v120, v120, 0xbdd2d3e8, v182
  v_fmamk_f32 v121, v121, 0xbdd2d3e8, v182
  v_fmamk_f32 v122, v122, 0xbdd2d3e8, v182
  v_fmamk_f32 v123, v123, 0xbdd2d3e8, v182
  v_fmamk_f32 v124, v124, 0xbdd2d3e8, v182
  v_fmamk_f32 v125, v125, 0xbdd2d3e8, v182
  v_fmamk_f32 v126, v126, 0xbdd2d3e8, v182
  v_fmamk_f32 v127, v127, 0xbdd2d3e8, v182
  v_fmamk_f32 v128, v128, 0xbdd2d3e8, v182
  v_fmamk_f32 v129, v129, 0xbdd2d3e8, v182
  v_fmamk_f32 v130, v130, 0xbdd2d3e8, v182
  v_fmamk_f32 v131, v131, 0xbdd2d3e8, v182
  v_fmamk_f32 v132, v132, 0xbdd2d3e8, v182
  v_fmamk_f32 v133, v133, 0xbdd2d3e8, v182
  v_fmamk_f32 v134, v134, 0xbdd2d3e8, v182
  v_fmamk_f32 v135, v135, 0xbdd2d3e8, v182
  v_fmamk_f32 v136, v136, 0xbdd2d3e8, v182
  v_fmamk_f32 v137, v137, 0xbdd2d3e8, v182
  v_fmamk_f32 v138, v138, 0xbdd2d3e8, v182
  v_fmamk_f32 v139, v139, 0xbdd2d3e8, v182
  v_fmamk_f32 v140, v140, 0xbdd2d3e8, v182
  v_fmamk_f32 v141, v141, 0xbdd2d3e8, v182
  v_fmamk_f32 v142, v142, 0xbdd2d3e8, v182
  v_fmamk_f32 v143, v143, 0xbdd2d3e8, v182
  v_fmamk_f32 v144, v144, 0xbdd2d3e8, v182
  v_fmamk_f32 v145, v145, 0xbdd2d3e8, v182
  v_fmamk_f32 v146, v146, 0xbdd2d3e8, v182
  v_fmamk_f32 v147, v147, 0xbdd2d3e8, v182
  v_fmamk_f32 v148, v148, 0xbdd2d3e8, v182
  v_fmamk_f32 v149, v149, 0xbdd2d3e8, v182
  v_mul_f32 v118, v86, v118
  v_mul_f32 v119, v87, v119
  v_mul_f32 v120, v88, v120
  v_mul_f32 v121, v89, v121
  v_mul_f32 v122, v90, v122
  v_mul_f32 v123, v91, v123
  v_mul_f32 v124, v92, v124
  v_mul_f32 v125, v93, v125
  v_mul_f32 v126, v94, v126
  v_mul_f32 v127, v95, v127
  v_mul_f32 v128, v96, v128
  v_mul_f32 v129, v97, v129
  v_mul_f32 v130, v98, v130
  v_mul_f32 v131, v99, v131
  v_mul_f32 v132, v100, v132
  v_mul_f32 v133, v101, v133
  v_mul_f32 v134, v102, v134
  v_mul_f32 v135, v103, v135
  v_mul_f32 v136, v104, v136
  v_mul_f32 v137, v105, v137
  v_mul_f32 v138, v106, v138
  v_mul_f32 v139, v107, v139
  v_mul_f32 v140, v108, v140
  v_mul_f32 v141, v109, v141
  v_mul_f32 v142, v110, v142
  v_mul_f32 v143, v111, v143
  v_mul_f32 v144, v112, v144
  v_mul_f32 v145, v113, v145
  v_mul_f32 v146, v114, v146
  v_mul_f32 v147, v115, v147
  v_mul_f32 v148, v116, v148
  v_mul_f32 v149, v117, v149
  v_exp_f32 v118, v118
  v_exp_f32 v119, v119
  v_exp_f32 v120, v120
  v_exp_f32 v121, v121
  v_exp_f32 v122, v122
  v_exp_f32 v123, v123
  v_exp_f32 v124, v124
  v_exp_f32 v125, v125
  v_exp_f32 v126, v126
  v_exp_f32 v127, v127
  v_exp_f32 v128, v128
  v_exp_f32 v129, v129
  v_exp_f32 v130, v130
  v_exp_f32 v131, v131
  v_exp_f32 v132, v132
  v_exp_f32 v133, v133
  v_exp_f32 v134, v134
  v_exp_f32 v135, v135
  v_exp_f32 v136, v136
  v_exp_f32 v137, v137
  v_exp_f32 v138, v138
  v_exp_f32 v139, v139
  v_exp_f32 v140, v140
  v_exp_f32 v141, v141
  v_exp_f32 v142, v142
  v_exp_f32 v143, v143
  v_exp_f32 v144, v144
  v_exp_f32 v145, v145
  v_exp_f32 v146, v146
  v_exp_f32 v147, v147
  v_exp_f32 v148, v148
  v_exp_f32 v149, v149
  v_add_f32 v118, 1.0, v118
  v_add_f32 v119, 1.0, v119
  v_add_f32 v120, 1.0, v120
  v_add_f32 v121, 1.0, v121
  v_add_f32 v122, 1.0, v122
  v_add_f32 v123, 1.0, v123
  v_add_f32 v124, 1.0, v124
  v_add_f32 v125, 1.0, v125
  v_add_f32 v126, 1.0, v126
  v_add_f32 v127, 1.0, v127
  v_add_f32 v128, 1.0, v128
  v_add_f32 v129, 1.0, v129
  v_add_f32 v130, 1.0, v130
  v_add_f32 v131, 1.0, v131
  v_add_f32 v132, 1.0, v132
  v_add_f32 v133, 1.0, v133
  v_add_f32 v134, 1.0, v134
  v_add_f32 v135, 1.0, v135
  v_add_f32 v136, 1.0, v136
  v_add_f32 v137, 1.0, v137
  v_add_f32 v138, 1.0, v138
  v_add_f32 v139, 1.0, v139
  v_add_f32 v140, 1.0, v140
  v_add_f32 v141, 1.0, v141
  v_add_f32 v142, 1.0, v142
  v_add_f32 v143, 1.0, v143
  v_add_f32 v144, 1.0, v144
  v_add_f32 v145, 1.0, v145
  v_add_f32 v146, 1.0, v146
  v_add_f32 v147, 1.0, v147
  v_add_f32 v148, 1.0, v148
  v_add_f32 v149, 1.0, v149
  v_rcp_f32 v118, v118
  v_rcp_f32 v119, v119
  v_rcp_f32 v120, v120
  v_rcp_f32 v121, v121
  v_rcp_f32 v122, v122
  v_rcp_f32 v123, v123
  v_rcp_f32 v124, v124
  v_rcp_f32 v125, v125
  v_rcp_f32 v126, v126
  v_rcp_f32 v127, v127
  v_rcp_f32 v128, v128
  v_rcp_f32 v129, v129
  v_rcp_f32 v130, v130
  v_rcp_f32 v131, v131
  v_rcp_f32 v132, v132
  v_rcp_f32 v133, v133
  v_rcp_f32 v134, v134
  v_rcp_f32 v135, v135
  v_rcp_f32 v136, v136
  v_rcp_f32 v137, v137
  v_rcp_f32 v138, v138
  v_rcp_f32 v139, v139
  v_rcp_f32 v140, v140
  v_rcp_f32 v141, v141
  v_rcp_f32 v142, v142
  v_rcp_f32 v143, v143
  v_rcp_f32 v144, v144
  v_rcp_f32 v145, v145
  v_rcp_f32 v146, v146
  v_rcp_f32 v147, v147
  v_rcp_f32 v148, v148
  v_rcp_f32 v149, v149
  v_mul_f32 v118, v86, v118
  v_mul_f32 v119, v87, v119
  v_mul_f32 v120, v88, v120
  v_mul_f32 v121, v89, v121
  v_mul_f32 v122, v90, v122
  v_mul_f32 v123, v91, v123
  v_mul_f32 v124, v92, v124
  v_mul_f32 v125, v93, v125
  v_mul_f32 v126, v94, v126
  v_mul_f32 v127, v95, v127
  v_mul_f32 v128, v96, v128
  v_mul_f32 v129, v97, v129
  v_mul_f32 v130, v98, v130
  v_mul_f32 v131, v99, v131
  v_mul_f32 v132, v100, v132
  v_mul_f32 v133, v101, v133
  v_mul_f32 v134, v102, v134
  v_mul_f32 v135, v103, v135
  v_mul_f32 v136, v104, v136
  v_mul_f32 v137, v105, v137
  v_mul_f32 v138, v106, v138
  v_mul_f32 v139, v107, v139
  v_mul_f32 v140, v108, v140
  v_mul_f32 v141, v109, v141
  v_mul_f32 v142, v110, v142
  v_mul_f32 v143, v111, v143
  v_mul_f32 v144, v112, v144
  v_mul_f32 v145, v113, v145
  v_mul_f32 v146, v114, v146
  v_mul_f32 v147, v115, v147
  v_mul_f32 v148, v116, v148
  v_mul_f32 v149, v117, v149
  v_cvt_pk_bf16_f32 v150, v118, v119
  v_cvt_pk_bf16_f32 v151, v120, v121
  v_cvt_pk_bf16_f32 v152, v122, v123
  v_cvt_pk_bf16_f32 v153, v124, v125
  v_cvt_pk_bf16_f32 v154, v126, v127
  v_cvt_pk_bf16_f32 v155, v128, v129
  v_cvt_pk_bf16_f32 v156, v130, v131
  v_cvt_pk_bf16_f32 v157, v132, v133
  v_cvt_pk_bf16_f32 v158, v134, v135
  v_cvt_pk_bf16_f32 v159, v136, v137
  v_cvt_pk_bf16_f32 v160, v138, v139
  v_cvt_pk_bf16_f32 v161, v140, v141
  v_cvt_pk_bf16_f32 v162, v142, v143
  v_cvt_pk_bf16_f32 v163, v144, v145
  v_cvt_pk_bf16_f32 v164, v146, v147
  v_cvt_pk_bf16_f32 v165, v148, v149
  v_dot2_f32_bf16 v166, v150, v78, v166
  v_dot2_f32_bf16 v166, v151, v79, v166
  v_dot2_f32_bf16 v167, v152, v78, v167
  v_dot2_f32_bf16 v167, v153, v79, v167
  v_dot2_f32_bf16 v168, v154, v78, v168
  v_dot2_f32_bf16 v168, v155, v79, v168
  v_dot2_f32_bf16 v169, v156, v78, v169
  v_dot2_f32_bf16 v169, v157, v79, v169
  v_dot2_f32_bf16 v170, v158, v78, v170
  v_dot2_f32_bf16 v170, v159, v79, v170
  v_dot2_f32_bf16 v171, v160, v78, v171
  v_dot2_f32_bf16 v171, v161, v79, v171
  v_dot2_f32_bf16 v172, v162, v78, v172
  v_dot2_f32_bf16 v172, v163, v79, v172
  v_dot2_f32_bf16 v173, v164, v78, v173
  v_dot2_f32_bf16 v173, v165, v79, v173
  s_nop 2
  v_mul_f32 v86, v174, v32
  v_mul_f32 v87, v174, v33
  v_mul_f32 v88, v174, v34
  v_mul_f32 v89, v174, v35
  v_mul_f32 v90, v175, v32
  v_mul_f32 v91, v175, v33
  v_mul_f32 v92, v175, v34
  v_mul_f32 v93, v175, v35
  v_mul_f32 v94, v176, v32
  v_mul_f32 v95, v176, v33
  v_mul_f32 v96, v176, v34
  v_mul_f32 v97, v176, v35
  v_mul_f32 v98, v177, v32
  v_mul_f32 v99, v177, v33
  v_mul_f32 v100, v177, v34
  v_mul_f32 v101, v177, v35
  v_mul_f32 v102, v178, v32
  v_mul_f32 v103, v178, v33
  v_mul_f32 v104, v178, v34
  v_mul_f32 v105, v178, v35
  v_mul_f32 v106, v179, v32
  v_mul_f32 v107, v179, v33
  v_mul_f32 v108, v179, v34
  v_mul_f32 v109, v179, v35
  v_mul_f32 v110, v180, v32
  v_mul_f32 v111, v180, v33
  v_mul_f32 v112, v180, v34
  v_mul_f32 v113, v180, v35
  v_mul_f32 v114, v181, v32
  v_mul_f32 v115, v181, v33
  v_mul_f32 v116, v181, v34
  v_mul_f32 v117, v181, v35
  v_cvt_pk_bf16_f32 v150, v86, v87
  v_cvt_pk_bf16_f32 v151, v88, v89
  v_cvt_pk_bf16_f32 v152, v90, v91
  v_cvt_pk_bf16_f32 v153, v92, v93
  v_cvt_pk_bf16_f32 v154, v94, v95
  v_cvt_pk_bf16_f32 v155, v96, v97
  v_cvt_pk_bf16_f32 v156, v98, v99
  v_cvt_pk_bf16_f32 v157, v100, v101
  v_cvt_pk_bf16_f32 v158, v102, v103
  v_cvt_pk_bf16_f32 v159, v104, v105
  v_cvt_pk_bf16_f32 v160, v106, v107
  v_cvt_pk_bf16_f32 v161, v108, v109
  v_cvt_pk_bf16_f32 v162, v110, v111
  v_cvt_pk_bf16_f32 v163, v112, v113
  v_cvt_pk_bf16_f32 v164, v114, v115
  v_cvt_pk_bf16_f32 v165, v116, v117
  v_dot2_f32_bf16 v86, v150, s69, v60
  v_dot2_f32_bf16 v87, v150, s70, v61
  v_dot2_f32_bf16 v88, v151, s69, v62
  v_dot2_f32_bf16 v89, v151, s70, v63
  v_dot2_f32_bf16 v90, v152, s69, v60
  v_dot2_f32_bf16 v91, v152, s70, v61
  v_dot2_f32_bf16 v92, v153, s69, v62
  v_dot2_f32_bf16 v93, v153, s70, v63
  v_dot2_f32_bf16 v94, v154, s69, v60
  v_dot2_f32_bf16 v95, v154, s70, v61
  v_dot2_f32_bf16 v96, v155, s69, v62
  v_dot2_f32_bf16 v97, v155, s70, v63
  v_dot2_f32_bf16 v98, v156, s69, v60
  v_dot2_f32_bf16 v99, v156, s70, v61
  v_dot2_f32_bf16 v100, v157, s69, v62
  v_dot2_f32_bf16 v101, v157, s70, v63
  v_dot2_f32_bf16 v102, v158, s69, v60
  v_dot2_f32_bf16 v103, v158, s70, v61
  v_dot2_f32_bf16 v104, v159, s69, v62
  v_dot2_f32_bf16 v105, v159, s70, v63
  v_dot2_f32_bf16 v106, v160, s69, v60
  v_dot2_f32_bf16 v107, v160, s70, v61
  v_dot2_f32_bf16 v108, v161, s69, v62
  v_dot2_f32_bf16 v109, v161, s70, v63
  v_dot2_f32_bf16 v110, v162, s69, v60
  v_dot2_f32_bf16 v111, v162, s70, v61
  v_dot2_f32_bf16 v112, v163, s69, v62
  v_dot2_f32_bf16 v113, v163, s70, v63
  v_dot2_f32_bf16 v114, v164, s69, v60
  v_dot2_f32_bf16 v115, v164, s70, v61
  v_dot2_f32_bf16 v116, v165, s69, v62
  v_dot2_f32_bf16 v117, v165, s70, v63
  v_cvt_pk_bf16_f32 v150, v86, v87
  v_cvt_pk_bf16_f32 v151, v88, v89
  v_cvt_pk_bf16_f32 v152, v90, v91
  v_cvt_pk_bf16_f32 v153, v92, v93
  v_cvt_pk_bf16_f32 v154, v94, v95
  v_cvt_pk_bf16_f32 v155, v96, v97
  v_cvt_pk_bf16_f32 v156, v98, v99
  v_cvt_pk_bf16_f32 v157, v100, v101
  v_cvt_pk_bf16_f32 v158, v102, v103
  v_cvt_pk_bf16_f32 v159, v104, v105
  v_cvt_pk_bf16_f32 v160, v106, v107
  v_cvt_pk_bf16_f32 v161, v108, v109
  v_cvt_pk_bf16_f32 v162, v110, v111
  v_cvt_pk_bf16_f32 v163, v112, v113
  v_cvt_pk_bf16_f32 v164, v114, v115
  v_cvt_pk_bf16_f32 v165, v116, v117
  v_lshlrev_b32 v86, 16, v150
  v_and_b32 v87, 0xffff0000, v150
  v_lshlrev_b32 v88, 16, v151
  v_and_b32 v89, 0xffff0000, v151
  v_lshlrev_b32 v90, 16, v152
  v_and_b32 v91, 0xffff0000, v152
  v_lshlrev_b32 v92, 16, v153
  v_and_b32 v93, 0xffff0000, v153
  v_lshlrev_b32 v94, 16, v154
  v_and_b32 v95, 0xffff0000, v154
  v_lshlrev_b32 v96, 16, v155
  v_and_b32 v97, 0xffff0000, v155
  v_lshlrev_b32 v98, 16, v156
  v_and_b32 v99, 0xffff0000, v156
  v_lshlrev_b32 v100, 16, v157
  v_and_b32 v101, 0xffff0000, v157
  v_lshlrev_b32 v102, 16, v158
  v_and_b32 v103, 0xffff0000, v158
  v_lshlrev_b32 v104, 16, v159
  v_and_b32 v105, 0xffff0000, v159
  v_lshlrev_b32 v106, 16, v160
  v_and_b32 v107, 0xffff0000, v160
  v_lshlrev_b32 v108, 16, v161
  v_and_b32 v109, 0xffff0000, v161
  v_lshlrev_b32 v110, 16, v162
  v_and_b32 v111, 0xffff0000, v162
  v_lshlrev_b32 v112, 16, v163
  v_and_b32 v113, 0xffff0000, v163
  v_lshlrev_b32 v114, 16, v164
  v_and_b32 v115, 0xffff0000, v164
  v_lshlrev_b32 v116, 16, v165
  v_and_b32 v117, 0xffff0000, v165
  v_mul_f32 v118, v86, v86
  v_mul_f32 v119, v87, v87
  v_mul_f32 v120, v88, v88
  v_mul_f32 v121, v89, v89
  v_mul_f32 v122, v90, v90
  v_mul_f32 v123, v91, v91
  v_mul_f32 v124, v92, v92
  v_mul_f32 v125, v93, v93
  v_mul_f32 v126, v94, v94
  v_mul_f32 v127, v95, v95
  v_mul_f32 v128, v96, v96
  v_mul_f32 v129, v97, v97
  v_mul_f32 v130, v98, v98
  v_mul_f32 v131, v99, v99
  v_mul_f32 v132, v100, v100
  v_mul_f32 v133, v101, v101
  v_mul_f32 v134, v102, v102
  v_mul_f32 v135, v103, v103
  v_mul_f32 v136, v104, v104
  v_mul_f32 v137, v105, v105
  v_mul_f32 v138, v106, v106
  v_mul_f32 v139, v107, v107
  v_mul_f32 v140, v108, v108
  v_mul_f32 v141, v109, v109
  v_mul_f32 v142, v110, v110
  v_mul_f32 v143, v111, v111
  v_mul_f32 v144, v112, v112
  v_mul_f32 v145, v113, v113
  v_mul_f32 v146, v114, v114
  v_mul_f32 v147, v115, v115
  v_mul_f32 v148, v116, v116
  v_mul_f32 v149, v117, v117
  v_fmamk_f32 v118, v118, 0xbdd2d3e8, v182
  v_fmamk_f32 v119, v119, 0xbdd2d3e8, v182
  v_fmamk_f32 v120, v120, 0xbdd2d3e8, v182
  v_fmamk_f32 v121, v121, 0xbdd2d3e8, v182
  v_fmamk_f32 v122, v122, 0xbdd2d3e8, v182
  v_fmamk_f32 v123, v123, 0xbdd2d3e8, v182
  v_fmamk_f32 v124, v124, 0xbdd2d3e8, v182
  v_fmamk_f32 v125, v125, 0xbdd2d3e8, v182
  v_fmamk_f32 v126, v126, 0xbdd2d3e8, v182
  v_fmamk_f32 v127, v127, 0xbdd2d3e8, v182
  v_fmamk_f32 v128, v128, 0xbdd2d3e8, v182
  v_fmamk_f32 v129, v129, 0xbdd2d3e8, v182
  v_fmamk_f32 v130, v130, 0xbdd2d3e8, v182
  v_fmamk_f32 v131, v131, 0xbdd2d3e8, v182
  v_fmamk_f32 v132, v132, 0xbdd2d3e8, v182
  v_fmamk_f32 v133, v133, 0xbdd2d3e8, v182
  v_fmamk_f32 v134, v134, 0xbdd2d3e8, v182
  v_fmamk_f32 v135, v135, 0xbdd2d3e8, v182
  v_fmamk_f32 v136, v136, 0xbdd2d3e8, v182
  v_fmamk_f32 v137, v137, 0xbdd2d3e8, v182
  v_fmamk_f32 v138, v138, 0xbdd2d3e8, v182
  v_fmamk_f32 v139, v139, 0xbdd2d3e8, v182
  v_fmamk_f32 v140, v140, 0xbdd2d3e8, v182
  v_fmamk_f32 v141, v141, 0xbdd2d3e8, v182
  v_fmamk_f32 v142, v142, 0xbdd2d3e8, v182
  v_fmamk_f32 v143, v143, 0xbdd2d3e8, v182
  v_fmamk_f32 v144, v144, 0xbdd2d3e8, v182
  v_fmamk_f32 v145, v145, 0xbdd2d3e8, v182
  v_fmamk_f32 v146, v146, 0xbdd2d3e8, v182
  v_fmamk_f32 v147, v147, 0xbdd2d3e8, v182
  v_fmamk_f32 v148, v148, 0xbdd2d3e8, v182
  v_fmamk_f32 v149, v149, 0xbdd2d3e8, v182
  v_mul_f32 v118, v86, v118
  v_mul_f32 v119, v87, v119
  v_mul_f32 v120, v88, v120
  v_mul_f32 v121, v89, v121
  v_mul_f32 v122, v90, v122
  v_mul_f32 v123, v91, v123
  v_mul_f32 v124, v92, v124
  v_mul_f32 v125, v93, v125
  v_mul_f32 v126, v94, v126
  v_mul_f32 v127, v95, v127
  v_mul_f32 v128, v96, v128
  v_mul_f32 v129, v97, v129
  v_mul_f32 v130, v98, v130
  v_mul_f32 v131, v99, v131
  v_mul_f32 v132, v100, v132
  v_mul_f32 v133, v101, v133
  v_mul_f32 v134, v102, v134
  v_mul_f32 v135, v103, v135
  v_mul_f32 v136, v104, v136
  v_mul_f32 v137, v105, v137
  v_mul_f32 v138, v106, v138
  v_mul_f32 v139, v107, v139
  v_mul_f32 v140, v108, v140
  v_mul_f32 v141, v109, v141
  v_mul_f32 v142, v110, v142
  v_mul_f32 v143, v111, v143
  v_mul_f32 v144, v112, v144
  v_mul_f32 v145, v113, v145
  v_mul_f32 v146, v114, v146
  v_mul_f32 v147, v115, v147
  v_mul_f32 v148, v116, v148
  v_mul_f32 v149, v117, v149
  v_exp_f32 v118, v118
  v_exp_f32 v119, v119
  v_exp_f32 v120, v120
  v_exp_f32 v121, v121
  v_exp_f32 v122, v122
  v_exp_f32 v123, v123
  v_exp_f32 v124, v124
  v_exp_f32 v125, v125
  v_exp_f32 v126, v126
  v_exp_f32 v127, v127
  v_exp_f32 v128, v128
  v_exp_f32 v129, v129
  v_exp_f32 v130, v130
  v_exp_f32 v131, v131
  v_exp_f32 v132, v132
  v_exp_f32 v133, v133
  v_exp_f32 v134, v134
  v_exp_f32 v135, v135
  v_exp_f32 v136, v136
  v_exp_f32 v137, v137
  v_exp_f32 v138, v138
  v_exp_f32 v139, v139
  v_exp_f32 v140, v140
  v_exp_f32 v141, v141
  v_exp_f32 v142, v142
  v_exp_f32 v143, v143
  v_exp_f32 v144, v144
  v_exp_f32 v145, v145
  v_exp_f32 v146, v146
  v_exp_f32 v147, v147
  v_exp_f32 v148, v148
  v_exp_f32 v149, v149
  v_add_f32 v118, 1.0, v118
  v_add_f32 v119, 1.0, v119
  v_add_f32 v120, 1.0, v120
  v_add_f32 v121, 1.0, v121
  v_add_f32 v122, 1.0, v122
  v_add_f32 v123, 1.0, v123
  v_add_f32 v124, 1.0, v124
  v_add_f32 v125, 1.0, v125
  v_add_f32 v126, 1.0, v126
  v_add_f32 v127, 1.0, v127
  v_add_f32 v128, 1.0, v128
  v_add_f32 v129, 1.0, v129
  v_add_f32 v130, 1.0, v130
  v_add_f32 v131, 1.0, v131
  v_add_f32 v132, 1.0, v132
  v_add_f32 v133, 1.0, v133
  v_add_f32 v134, 1.0, v134
  v_add_f32 v135, 1.0, v135
  v_add_f32 v136, 1.0, v136
  v_add_f32 v137, 1.0, v137
  v_add_f32 v138, 1.0, v138
  v_add_f32 v139, 1.0, v139
  v_add_f32 v140, 1.0, v140
  v_add_f32 v141, 1.0, v141
  v_add_f32 v142, 1.0, v142
  v_add_f32 v143, 1.0, v143
  v_add_f32 v144, 1.0, v144
  v_add_f32 v145, 1.0, v145
  v_add_f32 v146, 1.0, v146
  v_add_f32 v147, 1.0, v147
  v_add_f32 v148, 1.0, v148
  v_add_f32 v149, 1.0, v149
  v_rcp_f32 v118, v118
  v_rcp_f32 v119, v119
  v_rcp_f32 v120, v120
  v_rcp_f32 v121, v121
  v_rcp_f32 v122, v122
  v_rcp_f32 v123, v123
  v_rcp_f32 v124, v124
  v_rcp_f32 v125, v125
  v_rcp_f32 v126, v126
  v_rcp_f32 v127, v127
  v_rcp_f32 v128, v128
  v_rcp_f32 v129, v129
  v_rcp_f32 v130, v130
  v_rcp_f32 v131, v131
  v_rcp_f32 v132, v132
  v_rcp_f32 v133, v133
  v_rcp_f32 v134, v134
  v_rcp_f32 v135, v135
  v_rcp_f32 v136, v136
  v_rcp_f32 v137, v137
  v_rcp_f32 v138, v138
  v_rcp_f32 v139, v139
  v_rcp_f32 v140, v140
  v_rcp_f32 v141, v141
  v_rcp_f32 v142, v142
  v_rcp_f32 v143, v143
  v_rcp_f32 v144, v144
  v_rcp_f32 v145, v145
  v_rcp_f32 v146, v146
  v_rcp_f32 v147, v147
  v_rcp_f32 v148, v148
  v_rcp_f32 v149, v149
  v_mul_f32 v118, v86, v118
  v_mul_f32 v119, v87, v119
  v_mul_f32 v120, v88, v120
  v_mul_f32 v121, v89, v121
  v_mul_f32 v122, v90, v122
  v_mul_f32 v123, v91, v123
  v_mul_f32 v124, v92, v124
  v_mul_f32 v125, v93, v125
  v_mul_f32 v126, v94, v126
  v_mul_f32 v127, v95, v127
  v_mul_f32 v128, v96, v128
  v_mul_f32 v129, v97, v129
  v_mul_f32 v130, v98, v130
  v_mul_f32 v131, v99, v131
  v_mul_f32 v132, v100, v132
  v_mul_f32 v133, v101, v133
  v_mul_f32 v134, v102, v134
  v_mul_f32 v135, v103, v135
  v_mul_f32 v136, v104, v136
  v_mul_f32 v137, v105, v137
  v_mul_f32 v138, v106, v138
  v_mul_f32 v139, v107, v139
  v_mul_f32 v140, v108, v140
  v_mul_f32 v141, v109, v141
  v_mul_f32 v142, v110, v142
  v_mul_f32 v143, v111, v143
  v_mul_f32 v144, v112, v144
  v_mul_f32 v145, v113, v145
  v_mul_f32 v146, v114, v146
  v_mul_f32 v147, v115, v147
  v_mul_f32 v148, v116, v148
  v_mul_f32 v149, v117, v149
  v_cvt_pk_bf16_f32 v150, v118, v119
  v_cvt_pk_bf16_f32 v151, v120, v121
  v_cvt_pk_bf16_f32 v152, v122, v123
  v_cvt_pk_bf16_f32 v153, v124, v125
  v_cvt_pk_bf16_f32 v154, v126, v127
  v_cvt_pk_bf16_f32 v155, v128, v129
  v_cvt_pk_bf16_f32 v156, v130, v131
  v_cvt_pk_bf16_f32 v157, v132, v133
  v_cvt_pk_bf16_f32 v158, v134, v135
  v_cvt_pk_bf16_f32 v159, v136, v137
  v_cvt_pk_bf16_f32 v160, v138, v139
  v_cvt_pk_bf16_f32 v161, v140, v141
  v_cvt_pk_bf16_f32 v162, v142, v143
  v_cvt_pk_bf16_f32 v163, v144, v145
  v_cvt_pk_bf16_f32 v164, v146, v147
  v_cvt_pk_bf16_f32 v165, v148, v149
  v_dot2_f32_bf16 v166, v150, v80, v166
  v_dot2_f32_bf16 v166, v151, v81, v166
  v_dot2_f32_bf16 v167, v152, v80, v167
  v_dot2_f32_bf16 v167, v153, v81, v167
  v_dot2_f32_bf16 v168, v154, v80, v168
  v_dot2_f32_bf16 v168, v155, v81, v168
  v_dot2_f32_bf16 v169, v156, v80, v169
  v_dot2_f32_bf16 v169, v157, v81, v169
  v_dot2_f32_bf16 v170, v158, v80, v170
  v_dot2_f32_bf16 v170, v159, v81, v170
  v_dot2_f32_bf16 v171, v160, v80, v171
  v_dot2_f32_bf16 v171, v161, v81, v171
  v_dot2_f32_bf16 v172, v162, v80, v172
  v_dot2_f32_bf16 v172, v163, v81, v172
  v_dot2_f32_bf16 v173, v164, v80, v173
  v_dot2_f32_bf16 v173, v165, v81, v173
  s_nop 2
  v_mul_f32 v86, v174, v36
  v_mul_f32 v87, v174, v37
  v_mul_f32 v88, v174, v38
  v_mul_f32 v89, v174, v39
  v_mul_f32 v90, v175, v36
  v_mul_f32 v91, v175, v37
  v_mul_f32 v92, v175, v38
  v_mul_f32 v93, v175, v39
  v_mul_f32 v94, v176, v36
  v_mul_f32 v95, v176, v37
  v_mul_f32 v96, v176, v38
  v_mul_f32 v97, v176, v39
  v_mul_f32 v98, v177, v36
  v_mul_f32 v99, v177, v37
  v_mul_f32 v100, v177, v38
  v_mul_f32 v101, v177, v39
  v_mul_f32 v102, v178, v36
  v_mul_f32 v103, v178, v37
  v_mul_f32 v104, v178, v38
  v_mul_f32 v105, v178, v39
  v_mul_f32 v106, v179, v36
  v_mul_f32 v107, v179, v37
  v_mul_f32 v108, v179, v38
  v_mul_f32 v109, v179, v39
  v_mul_f32 v110, v180, v36
  v_mul_f32 v111, v180, v37
  v_mul_f32 v112, v180, v38
  v_mul_f32 v113, v180, v39
  v_mul_f32 v114, v181, v36
  v_mul_f32 v115, v181, v37
  v_mul_f32 v116, v181, v38
  v_mul_f32 v117, v181, v39
  v_cvt_pk_bf16_f32 v150, v86, v87
  v_cvt_pk_bf16_f32 v151, v88, v89
  v_cvt_pk_bf16_f32 v152, v90, v91
  v_cvt_pk_bf16_f32 v153, v92, v93
  v_cvt_pk_bf16_f32 v154, v94, v95
  v_cvt_pk_bf16_f32 v155, v96, v97
  v_cvt_pk_bf16_f32 v156, v98, v99
  v_cvt_pk_bf16_f32 v157, v100, v101
  v_cvt_pk_bf16_f32 v158, v102, v103
  v_cvt_pk_bf16_f32 v159, v104, v105
  v_cvt_pk_bf16_f32 v160, v106, v107
  v_cvt_pk_bf16_f32 v161, v108, v109
  v_cvt_pk_bf16_f32 v162, v110, v111
  v_cvt_pk_bf16_f32 v163, v112, v113
  v_cvt_pk_bf16_f32 v164, v114, v115
  v_cvt_pk_bf16_f32 v165, v116, v117
  v_dot2_f32_bf16 v86, v150, s69, v64
  v_dot2_f32_bf16 v87, v150, s70, v65
  v_dot2_f32_bf16 v88, v151, s69, v66
  v_dot2_f32_bf16 v89, v151, s70, v67
  v_dot2_f32_bf16 v90, v152, s69, v64
  v_dot2_f32_bf16 v91, v152, s70, v65
  v_dot2_f32_bf16 v92, v153, s69, v66
  v_dot2_f32_bf16 v93, v153, s70, v67
  v_dot2_f32_bf16 v94, v154, s69, v64
  v_dot2_f32_bf16 v95, v154, s70, v65
  v_dot2_f32_bf16 v96, v155, s69, v66
  v_dot2_f32_bf16 v97, v155, s70, v67
  v_dot2_f32_bf16 v98, v156, s69, v64
  v_dot2_f32_bf16 v99, v156, s70, v65
  v_dot2_f32_bf16 v100, v157, s69, v66
  v_dot2_f32_bf16 v101, v157, s70, v67
  v_dot2_f32_bf16 v102, v158, s69, v64
  v_dot2_f32_bf16 v103, v158, s70, v65
  v_dot2_f32_bf16 v104, v159, s69, v66
  v_dot2_f32_bf16 v105, v159, s70, v67
  v_dot2_f32_bf16 v106, v160, s69, v64
  v_dot2_f32_bf16 v107, v160, s70, v65
  v_dot2_f32_bf16 v108, v161, s69, v66
  v_dot2_f32_bf16 v109, v161, s70, v67
  v_dot2_f32_bf16 v110, v162, s69, v64
  v_dot2_f32_bf16 v111, v162, s70, v65
  v_dot2_f32_bf16 v112, v163, s69, v66
  v_dot2_f32_bf16 v113, v163, s70, v67
  v_dot2_f32_bf16 v114, v164, s69, v64
  v_dot2_f32_bf16 v115, v164, s70, v65
  v_dot2_f32_bf16 v116, v165, s69, v66
  v_dot2_f32_bf16 v117, v165, s70, v67
  v_cvt_pk_bf16_f32 v150, v86, v87
  v_cvt_pk_bf16_f32 v151, v88, v89
  v_cvt_pk_bf16_f32 v152, v90, v91
  v_cvt_pk_bf16_f32 v153, v92, v93
  v_cvt_pk_bf16_f32 v154, v94, v95
  v_cvt_pk_bf16_f32 v155, v96, v97
  v_cvt_pk_bf16_f32 v156, v98, v99
  v_cvt_pk_bf16_f32 v157, v100, v101
  v_cvt_pk_bf16_f32 v158, v102, v103
  v_cvt_pk_bf16_f32 v159, v104, v105
  v_cvt_pk_bf16_f32 v160, v106, v107
  v_cvt_pk_bf16_f32 v161, v108, v109
  v_cvt_pk_bf16_f32 v162, v110, v111
  v_cvt_pk_bf16_f32 v163, v112, v113
  v_cvt_pk_bf16_f32 v164, v114, v115
  v_cvt_pk_bf16_f32 v165, v116, v117
  v_lshlrev_b32 v86, 16, v150
  v_and_b32 v87, 0xffff0000, v150
  v_lshlrev_b32 v88, 16, v151
  v_and_b32 v89, 0xffff0000, v151
  v_lshlrev_b32 v90, 16, v152
  v_and_b32 v91, 0xffff0000, v152
  v_lshlrev_b32 v92, 16, v153
  v_and_b32 v93, 0xffff0000, v153
  v_lshlrev_b32 v94, 16, v154
  v_and_b32 v95, 0xffff0000, v154
  v_lshlrev_b32 v96, 16, v155
  v_and_b32 v97, 0xffff0000, v155
  v_lshlrev_b32 v98, 16, v156
  v_and_b32 v99, 0xffff0000, v156
  v_lshlrev_b32 v100, 16, v157
  v_and_b32 v101, 0xffff0000, v157
  v_lshlrev_b32 v102, 16, v158
  v_and_b32 v103, 0xffff0000, v158
  v_lshlrev_b32 v104, 16, v159
  v_and_b32 v105, 0xffff0000, v159
  v_lshlrev_b32 v106, 16, v160
  v_and_b32 v107, 0xffff0000, v160
  v_lshlrev_b32 v108, 16, v161
  v_and_b32 v109, 0xffff0000, v161
  v_lshlrev_b32 v110, 16, v162
  v_and_b32 v111, 0xffff0000, v162
  v_lshlrev_b32 v112, 16, v163
  v_and_b32 v113, 0xffff0000, v163
  v_lshlrev_b32 v114, 16, v164
  v_and_b32 v115, 0xffff0000, v164
  v_lshlrev_b32 v116, 16, v165
  v_and_b32 v117, 0xffff0000, v165
  v_mul_f32 v118, v86, v86
  v_mul_f32 v119, v87, v87
  v_mul_f32 v120, v88, v88
  v_mul_f32 v121, v89, v89
  v_mul_f32 v122, v90, v90
  v_mul_f32 v123, v91, v91
  v_mul_f32 v124, v92, v92
  v_mul_f32 v125, v93, v93
  v_mul_f32 v126, v94, v94
  v_mul_f32 v127, v95, v95
  v_mul_f32 v128, v96, v96
  v_mul_f32 v129, v97, v97
  v_mul_f32 v130, v98, v98
  v_mul_f32 v131, v99, v99
  v_mul_f32 v132, v100, v100
  v_mul_f32 v133, v101, v101
  v_mul_f32 v134, v102, v102
  v_mul_f32 v135, v103, v103
  v_mul_f32 v136, v104, v104
  v_mul_f32 v137, v105, v105
  v_mul_f32 v138, v106, v106
  v_mul_f32 v139, v107, v107
  v_mul_f32 v140, v108, v108
  v_mul_f32 v141, v109, v109
  v_mul_f32 v142, v110, v110
  v_mul_f32 v143, v111, v111
  v_mul_f32 v144, v112, v112
  v_mul_f32 v145, v113, v113
  v_mul_f32 v146, v114, v114
  v_mul_f32 v147, v115, v115
  v_mul_f32 v148, v116, v116
  v_mul_f32 v149, v117, v117
  v_fmamk_f32 v118, v118, 0xbdd2d3e8, v182
  v_fmamk_f32 v119, v119, 0xbdd2d3e8, v182
  v_fmamk_f32 v120, v120, 0xbdd2d3e8, v182
  v_fmamk_f32 v121, v121, 0xbdd2d3e8, v182
  v_fmamk_f32 v122, v122, 0xbdd2d3e8, v182
  v_fmamk_f32 v123, v123, 0xbdd2d3e8, v182
  v_fmamk_f32 v124, v124, 0xbdd2d3e8, v182
  v_fmamk_f32 v125, v125, 0xbdd2d3e8, v182
  v_fmamk_f32 v126, v126, 0xbdd2d3e8, v182
  v_fmamk_f32 v127, v127, 0xbdd2d3e8, v182
  v_fmamk_f32 v128, v128, 0xbdd2d3e8, v182
  v_fmamk_f32 v129, v129, 0xbdd2d3e8, v182
  v_fmamk_f32 v130, v130, 0xbdd2d3e8, v182
  v_fmamk_f32 v131, v131, 0xbdd2d3e8, v182
  v_fmamk_f32 v132, v132, 0xbdd2d3e8, v182
  v_fmamk_f32 v133, v133, 0xbdd2d3e8, v182
  v_fmamk_f32 v134, v134, 0xbdd2d3e8, v182
  v_fmamk_f32 v135, v135, 0xbdd2d3e8, v182
  v_fmamk_f32 v136, v136, 0xbdd2d3e8, v182
  v_fmamk_f32 v137, v137, 0xbdd2d3e8, v182
  v_fmamk_f32 v138, v138, 0xbdd2d3e8, v182
  v_fmamk_f32 v139, v139, 0xbdd2d3e8, v182
  v_fmamk_f32 v140, v140, 0xbdd2d3e8, v182
  v_fmamk_f32 v141, v141, 0xbdd2d3e8, v182
  v_fmamk_f32 v142, v142, 0xbdd2d3e8, v182
  v_fmamk_f32 v143, v143, 0xbdd2d3e8, v182
  v_fmamk_f32 v144, v144, 0xbdd2d3e8, v182
  v_fmamk_f32 v145, v145, 0xbdd2d3e8, v182
  v_fmamk_f32 v146, v146, 0xbdd2d3e8, v182
  v_fmamk_f32 v147, v147, 0xbdd2d3e8, v182
  v_fmamk_f32 v148, v148, 0xbdd2d3e8, v182
  v_fmamk_f32 v149, v149, 0xbdd2d3e8, v182
  v_mul_f32 v118, v86, v118
  v_mul_f32 v119, v87, v119
  v_mul_f32 v120, v88, v120
  v_mul_f32 v121, v89, v121
  v_mul_f32 v122, v90, v122
  v_mul_f32 v123, v91, v123
  v_mul_f32 v124, v92, v124
  v_mul_f32 v125, v93, v125
  v_mul_f32 v126, v94, v126
  v_mul_f32 v127, v95, v127
  v_mul_f32 v128, v96, v128
  v_mul_f32 v129, v97, v129
  v_mul_f32 v130, v98, v130
  v_mul_f32 v131, v99, v131
  v_mul_f32 v132, v100, v132
  v_mul_f32 v133, v101, v133
  v_mul_f32 v134, v102, v134
  v_mul_f32 v135, v103, v135
  v_mul_f32 v136, v104, v136
  v_mul_f32 v137, v105, v137
  v_mul_f32 v138, v106, v138
  v_mul_f32 v139, v107, v139
  v_mul_f32 v140, v108, v140
  v_mul_f32 v141, v109, v141
  v_mul_f32 v142, v110, v142
  v_mul_f32 v143, v111, v143
  v_mul_f32 v144, v112, v144
  v_mul_f32 v145, v113, v145
  v_mul_f32 v146, v114, v146
  v_mul_f32 v147, v115, v147
  v_mul_f32 v148, v116, v148
  v_mul_f32 v149, v117, v149
  v_exp_f32 v118, v118
  v_exp_f32 v119, v119
  v_exp_f32 v120, v120
  v_exp_f32 v121, v121
  v_exp_f32 v122, v122
  v_exp_f32 v123, v123
  v_exp_f32 v124, v124
  v_exp_f32 v125, v125
  v_exp_f32 v126, v126
  v_exp_f32 v127, v127
  v_exp_f32 v128, v128
  v_exp_f32 v129, v129
  v_exp_f32 v130, v130
  v_exp_f32 v131, v131
  v_exp_f32 v132, v132
  v_exp_f32 v133, v133
  v_exp_f32 v134, v134
  v_exp_f32 v135, v135
  v_exp_f32 v136, v136
  v_exp_f32 v137, v137
  v_exp_f32 v138, v138
  v_exp_f32 v139, v139
  v_exp_f32 v140, v140
  v_exp_f32 v141, v141
  v_exp_f32 v142, v142
  v_exp_f32 v143, v143
  v_exp_f32 v144, v144
  v_exp_f32 v145, v145
  v_exp_f32 v146, v146
  v_exp_f32 v147, v147
  v_exp_f32 v148, v148
  v_exp_f32 v149, v149
  v_add_f32 v118, 1.0, v118
  v_add_f32 v119, 1.0, v119
  v_add_f32 v120, 1.0, v120
  v_add_f32 v121, 1.0, v121
  v_add_f32 v122, 1.0, v122
  v_add_f32 v123, 1.0, v123
  v_add_f32 v124, 1.0, v124
  v_add_f32 v125, 1.0, v125
  v_add_f32 v126, 1.0, v126
  v_add_f32 v127, 1.0, v127
  v_add_f32 v128, 1.0, v128
  v_add_f32 v129, 1.0, v129
  v_add_f32 v130, 1.0, v130
  v_add_f32 v131, 1.0, v131
  v_add_f32 v132, 1.0, v132
  v_add_f32 v133, 1.0, v133
  v_add_f32 v134, 1.0, v134
  v_add_f32 v135, 1.0, v135
  v_add_f32 v136, 1.0, v136
  v_add_f32 v137, 1.0, v137
  v_add_f32 v138, 1.0, v138
  v_add_f32 v139, 1.0, v139
  v_add_f32 v140, 1.0, v140
  v_add_f32 v141, 1.0, v141
  v_add_f32 v142, 1.0, v142
  v_add_f32 v143, 1.0, v143
  v_add_f32 v144, 1.0, v144
  v_add_f32 v145, 1.0, v145
  v_add_f32 v146, 1.0, v146
  v_add_f32 v147, 1.0, v147
  v_add_f32 v148, 1.0, v148
  v_add_f32 v149, 1.0, v149
  v_rcp_f32 v118, v118
  v_rcp_f32 v119, v119
  v_rcp_f32 v120, v120
  v_rcp_f32 v121, v121
  v_rcp_f32 v122, v122
  v_rcp_f32 v123, v123
  v_rcp_f32 v124, v124
  v_rcp_f32 v125, v125
  v_rcp_f32 v126, v126
  v_rcp_f32 v127, v127
  v_rcp_f32 v128, v128
  v_rcp_f32 v129, v129
  v_rcp_f32 v130, v130
  v_rcp_f32 v131, v131
  v_rcp_f32 v132, v132
  v_rcp_f32 v133, v133
  v_rcp_f32 v134, v134
  v_rcp_f32 v135, v135
  v_rcp_f32 v136, v136
  v_rcp_f32 v137, v137
  v_rcp_f32 v138, v138
  v_rcp_f32 v139, v139
  v_rcp_f32 v140, v140
  v_rcp_f32 v141, v141
  v_rcp_f32 v142, v142
  v_rcp_f32 v143, v143
  v_rcp_f32 v144, v144
  v_rcp_f32 v145, v145
  v_rcp_f32 v146, v146
  v_rcp_f32 v147, v147
  v_rcp_f32 v148, v148
  v_rcp_f32 v149, v149
  v_mul_f32 v118, v86, v118
  v_mul_f32 v119, v87, v119
  v_mul_f32 v120, v88, v120
  v_mul_f32 v121, v89, v121
  v_mul_f32 v122, v90, v122
  v_mul_f32 v123, v91, v123
  v_mul_f32 v124, v92, v124
  v_mul_f32 v125, v93, v125
  v_mul_f32 v126, v94, v126
  v_mul_f32 v127, v95, v127
  v_mul_f32 v128, v96, v128
  v_mul_f32 v129, v97, v129
  v_mul_f32 v130, v98, v130
  v_mul_f32 v131, v99, v131
  v_mul_f32 v132, v100, v132
  v_mul_f32 v133, v101, v133
  v_mul_f32 v134, v102, v134
  v_mul_f32 v135, v103, v135
  v_mul_f32 v136, v104, v136
  v_mul_f32 v137, v105, v137
  v_mul_f32 v138, v106, v138
  v_mul_f32 v139, v107, v139
  v_mul_f32 v140, v108, v140
  v_mul_f32 v141, v109, v141
  v_mul_f32 v142, v110, v142
  v_mul_f32 v143, v111, v143
  v_mul_f32 v144, v112, v144
  v_mul_f32 v145, v113, v145
  v_mul_f32 v146, v114, v146
  v_mul_f32 v147, v115, v147
  v_mul_f32 v148, v116, v148
  v_mul_f32 v149, v117, v149
  v_cvt_pk_bf16_f32 v150, v118, v119
  v_cvt_pk_bf16_f32 v151, v120, v121
  v_cvt_pk_bf16_f32 v152, v122, v123
  v_cvt_pk_bf16_f32 v153, v124, v125
  v_cvt_pk_bf16_f32 v154, v126, v127
  v_cvt_pk_bf16_f32 v155, v128, v129
  v_cvt_pk_bf16_f32 v156, v130, v131
  v_cvt_pk_bf16_f32 v157, v132, v133
  v_cvt_pk_bf16_f32 v158, v134, v135
  v_cvt_pk_bf16_f32 v159, v136, v137
  v_cvt_pk_bf16_f32 v160, v138, v139
  v_cvt_pk_bf16_f32 v161, v140, v141
  v_cvt_pk_bf16_f32 v162, v142, v143
  v_cvt_pk_bf16_f32 v163, v144, v145
  v_cvt_pk_bf16_f32 v164, v146, v147
  v_cvt_pk_bf16_f32 v165, v148, v149
  v_dot2_f32_bf16 v166, v150, v82, v166
  v_dot2_f32_bf16 v166, v151, v83, v166
  v_dot2_f32_bf16 v167, v152, v82, v167
  v_dot2_f32_bf16 v167, v153, v83, v167
  v_dot2_f32_bf16 v168, v154, v82, v168
  v_dot2_f32_bf16 v168, v155, v83, v168
  v_dot2_f32_bf16 v169, v156, v82, v169
  v_dot2_f32_bf16 v169, v157, v83, v169
  v_dot2_f32_bf16 v170, v158, v82, v170
  v_dot2_f32_bf16 v170, v159, v83, v170
  v_dot2_f32_bf16 v171, v160, v82, v171
  v_dot2_f32_bf16 v171, v161, v83, v171
  v_dot2_f32_bf16 v172, v162, v82, v172
  v_dot2_f32_bf16 v172, v163, v83, v172
  v_dot2_f32_bf16 v173, v164, v82, v173
  v_dot2_f32_bf16 v173, v165, v83, v173
  s_nop 2
  v_mul_f32 v86, v174, v40
  v_mul_f32 v87, v174, v41
  v_mul_f32 v88, v174, v42
  v_mul_f32 v89, v174, v43
  v_mul_f32 v90, v175, v40
  v_mul_f32 v91, v175, v41
  v_mul_f32 v92, v175, v42
  v_mul_f32 v93, v175, v43
  v_mul_f32 v94, v176, v40
  v_mul_f32 v95, v176, v41
  v_mul_f32 v96, v176, v42
  v_mul_f32 v97, v176, v43
  v_mul_f32 v98, v177, v40
  v_mul_f32 v99, v177, v41
  v_mul_f32 v100, v177, v42
  v_mul_f32 v101, v177, v43
  v_mul_f32 v102, v178, v40
  v_mul_f32 v103, v178, v41
  v_mul_f32 v104, v178, v42
  v_mul_f32 v105, v178, v43
  v_mul_f32 v106, v179, v40
  v_mul_f32 v107, v179, v41
  v_mul_f32 v108, v179, v42
  v_mul_f32 v109, v179, v43
  v_mul_f32 v110, v180, v40
  v_mul_f32 v111, v180, v41
  v_mul_f32 v112, v180, v42
  v_mul_f32 v113, v180, v43
  v_mul_f32 v114, v181, v40
  v_mul_f32 v115, v181, v41
  v_mul_f32 v116, v181, v42
  v_mul_f32 v117, v181, v43
  v_cvt_pk_bf16_f32 v150, v86, v87
  v_cvt_pk_bf16_f32 v151, v88, v89
  v_cvt_pk_bf16_f32 v152, v90, v91
  v_cvt_pk_bf16_f32 v153, v92, v93
  v_cvt_pk_bf16_f32 v154, v94, v95
  v_cvt_pk_bf16_f32 v155, v96, v97
  v_cvt_pk_bf16_f32 v156, v98, v99
  v_cvt_pk_bf16_f32 v157, v100, v101
  v_cvt_pk_bf16_f32 v158, v102, v103
  v_cvt_pk_bf16_f32 v159, v104, v105
  v_cvt_pk_bf16_f32 v160, v106, v107
  v_cvt_pk_bf16_f32 v161, v108, v109
  v_cvt_pk_bf16_f32 v162, v110, v111
  v_cvt_pk_bf16_f32 v163, v112, v113
  v_cvt_pk_bf16_f32 v164, v114, v115
  v_cvt_pk_bf16_f32 v165, v116, v117
  v_dot2_f32_bf16 v86, v150, s69, v68
  v_dot2_f32_bf16 v87, v150, s70, v69
  v_dot2_f32_bf16 v88, v151, s69, v70
  v_dot2_f32_bf16 v89, v151, s70, v71
  v_dot2_f32_bf16 v90, v152, s69, v68
  v_dot2_f32_bf16 v91, v152, s70, v69
  v_dot2_f32_bf16 v92, v153, s69, v70
  v_dot2_f32_bf16 v93, v153, s70, v71
  v_dot2_f32_bf16 v94, v154, s69, v68
  v_dot2_f32_bf16 v95, v154, s70, v69
  v_dot2_f32_bf16 v96, v155, s69, v70
  v_dot2_f32_bf16 v97, v155, s70, v71
  v_dot2_f32_bf16 v98, v156, s69, v68
  v_dot2_f32_bf16 v99, v156, s70, v69
  v_dot2_f32_bf16 v100, v157, s69, v70
  v_dot2_f32_bf16 v101, v157, s70, v71
  v_dot2_f32_bf16 v102, v158, s69, v68
  v_dot2_f32_bf16 v103, v158, s70, v69
  v_dot2_f32_bf16 v104, v159, s69, v70
  v_dot2_f32_bf16 v105, v159, s70, v71
  v_dot2_f32_bf16 v106, v160, s69, v68
  v_dot2_f32_bf16 v107, v160, s70, v69
  v_dot2_f32_bf16 v108, v161, s69, v70
  v_dot2_f32_bf16 v109, v161, s70, v71
  v_dot2_f32_bf16 v110, v162, s69, v68
  v_dot2_f32_bf16 v111, v162, s70, v69
  v_dot2_f32_bf16 v112, v163, s69, v70
  v_dot2_f32_bf16 v113, v163, s70, v71
  v_dot2_f32_bf16 v114, v164, s69, v68
  v_dot2_f32_bf16 v115, v164, s70, v69
  v_dot2_f32_bf16 v116, v165, s69, v70
  v_dot2_f32_bf16 v117, v165, s70, v71
  v_cvt_pk_bf16_f32 v150, v86, v87
  v_cvt_pk_bf16_f32 v151, v88, v89
  v_cvt_pk_bf16_f32 v152, v90, v91
  v_cvt_pk_bf16_f32 v153, v92, v93
  v_cvt_pk_bf16_f32 v154, v94, v95
  v_cvt_pk_bf16_f32 v155, v96, v97
  v_cvt_pk_bf16_f32 v156, v98, v99
  v_cvt_pk_bf16_f32 v157, v100, v101
  v_cvt_pk_bf16_f32 v158, v102, v103
  v_cvt_pk_bf16_f32 v159, v104, v105
  v_cvt_pk_bf16_f32 v160, v106, v107
  v_cvt_pk_bf16_f32 v161, v108, v109
  v_cvt_pk_bf16_f32 v162, v110, v111
  v_cvt_pk_bf16_f32 v163, v112, v113
  v_cvt_pk_bf16_f32 v164, v114, v115
  v_cvt_pk_bf16_f32 v165, v116, v117
  v_lshlrev_b32 v86, 16, v150
  v_and_b32 v87, 0xffff0000, v150
  v_lshlrev_b32 v88, 16, v151
  v_and_b32 v89, 0xffff0000, v151
  v_lshlrev_b32 v90, 16, v152
  v_and_b32 v91, 0xffff0000, v152
  v_lshlrev_b32 v92, 16, v153
  v_and_b32 v93, 0xffff0000, v153
  v_lshlrev_b32 v94, 16, v154
  v_and_b32 v95, 0xffff0000, v154
  v_lshlrev_b32 v96, 16, v155
  v_and_b32 v97, 0xffff0000, v155
  v_lshlrev_b32 v98, 16, v156
  v_and_b32 v99, 0xffff0000, v156
  v_lshlrev_b32 v100, 16, v157
  v_and_b32 v101, 0xffff0000, v157
  v_lshlrev_b32 v102, 16, v158
  v_and_b32 v103, 0xffff0000, v158
  v_lshlrev_b32 v104, 16, v159
  v_and_b32 v105, 0xffff0000, v159
  v_lshlrev_b32 v106, 16, v160
  v_and_b32 v107, 0xffff0000, v160
  v_lshlrev_b32 v108, 16, v161
  v_and_b32 v109, 0xffff0000, v161
  v_lshlrev_b32 v110, 16, v162
  v_and_b32 v111, 0xffff0000, v162
  v_lshlrev_b32 v112, 16, v163
  v_and_b32 v113, 0xffff0000, v163
  v_lshlrev_b32 v114, 16, v164
  v_and_b32 v115, 0xffff0000, v164
  v_lshlrev_b32 v116, 16, v165
  v_and_b32 v117, 0xffff0000, v165
  v_mul_f32 v118, v86, v86
  v_mul_f32 v119, v87, v87
  v_mul_f32 v120, v88, v88
  v_mul_f32 v121, v89, v89
  v_mul_f32 v122, v90, v90
  v_mul_f32 v123, v91, v91
  v_mul_f32 v124, v92, v92
  v_mul_f32 v125, v93, v93
  v_mul_f32 v126, v94, v94
  v_mul_f32 v127, v95, v95
  v_mul_f32 v128, v96, v96
  v_mul_f32 v129, v97, v97
  v_mul_f32 v130, v98, v98
  v_mul_f32 v131, v99, v99
  v_mul_f32 v132, v100, v100
  v_mul_f32 v133, v101, v101
  v_mul_f32 v134, v102, v102
  v_mul_f32 v135, v103, v103
  v_mul_f32 v136, v104, v104
  v_mul_f32 v137, v105, v105
  v_mul_f32 v138, v106, v106
  v_mul_f32 v139, v107, v107
  v_mul_f32 v140, v108, v108
  v_mul_f32 v141, v109, v109
  v_mul_f32 v142, v110, v110
  v_mul_f32 v143, v111, v111
  v_mul_f32 v144, v112, v112
  v_mul_f32 v145, v113, v113
  v_mul_f32 v146, v114, v114
  v_mul_f32 v147, v115, v115
  v_mul_f32 v148, v116, v116
  v_mul_f32 v149, v117, v117
  v_fmamk_f32 v118, v118, 0xbdd2d3e8, v182
  v_fmamk_f32 v119, v119, 0xbdd2d3e8, v182
  v_fmamk_f32 v120, v120, 0xbdd2d3e8, v182
  v_fmamk_f32 v121, v121, 0xbdd2d3e8, v182
  v_fmamk_f32 v122, v122, 0xbdd2d3e8, v182
  v_fmamk_f32 v123, v123, 0xbdd2d3e8, v182
  v_fmamk_f32 v124, v124, 0xbdd2d3e8, v182
  v_fmamk_f32 v125, v125, 0xbdd2d3e8, v182
  v_fmamk_f32 v126, v126, 0xbdd2d3e8, v182
  v_fmamk_f32 v127, v127, 0xbdd2d3e8, v182
  v_fmamk_f32 v128, v128, 0xbdd2d3e8, v182
  v_fmamk_f32 v129, v129, 0xbdd2d3e8, v182
  v_fmamk_f32 v130, v130, 0xbdd2d3e8, v182
  v_fmamk_f32 v131, v131, 0xbdd2d3e8, v182
  v_fmamk_f32 v132, v132, 0xbdd2d3e8, v182
  v_fmamk_f32 v133, v133, 0xbdd2d3e8, v182
  v_fmamk_f32 v134, v134, 0xbdd2d3e8, v182
  v_fmamk_f32 v135, v135, 0xbdd2d3e8, v182
  v_fmamk_f32 v136, v136, 0xbdd2d3e8, v182
  v_fmamk_f32 v137, v137, 0xbdd2d3e8, v182
  v_fmamk_f32 v138, v138, 0xbdd2d3e8, v182
  v_fmamk_f32 v139, v139, 0xbdd2d3e8, v182
  v_fmamk_f32 v140, v140, 0xbdd2d3e8, v182
  v_fmamk_f32 v141, v141, 0xbdd2d3e8, v182
  v_fmamk_f32 v142, v142, 0xbdd2d3e8, v182
  v_fmamk_f32 v143, v143, 0xbdd2d3e8, v182
  v_fmamk_f32 v144, v144, 0xbdd2d3e8, v182
  v_fmamk_f32 v145, v145, 0xbdd2d3e8, v182
  v_fmamk_f32 v146, v146, 0xbdd2d3e8, v182
  v_fmamk_f32 v147, v147, 0xbdd2d3e8, v182
  v_fmamk_f32 v148, v148, 0xbdd2d3e8, v182
  v_fmamk_f32 v149, v149, 0xbdd2d3e8, v182
  v_mul_f32 v118, v86, v118
  v_mul_f32 v119, v87, v119
  v_mul_f32 v120, v88, v120
  v_mul_f32 v121, v89, v121
  v_mul_f32 v122, v90, v122
  v_mul_f32 v123, v91, v123
  v_mul_f32 v124, v92, v124
  v_mul_f32 v125, v93, v125
  v_mul_f32 v126, v94, v126
  v_mul_f32 v127, v95, v127
  v_mul_f32 v128, v96, v128
  v_mul_f32 v129, v97, v129
  v_mul_f32 v130, v98, v130
  v_mul_f32 v131, v99, v131
  v_mul_f32 v132, v100, v132
  v_mul_f32 v133, v101, v133
  v_mul_f32 v134, v102, v134
  v_mul_f32 v135, v103, v135
  v_mul_f32 v136, v104, v136
  v_mul_f32 v137, v105, v137
  v_mul_f32 v138, v106, v138
  v_mul_f32 v139, v107, v139
  v_mul_f32 v140, v108, v140
  v_mul_f32 v141, v109, v141
  v_mul_f32 v142, v110, v142
  v_mul_f32 v143, v111, v143
  v_mul_f32 v144, v112, v144
  v_mul_f32 v145, v113, v145
  v_mul_f32 v146, v114, v146
  v_mul_f32 v147, v115, v147
  v_mul_f32 v148, v116, v148
  v_mul_f32 v149, v117, v149
  v_exp_f32 v118, v118
  v_exp_f32 v119, v119
  v_exp_f32 v120, v120
  v_exp_f32 v121, v121
  v_exp_f32 v122, v122
  v_exp_f32 v123, v123
  v_exp_f32 v124, v124
  v_exp_f32 v125, v125
  v_exp_f32 v126, v126
  v_exp_f32 v127, v127
  v_exp_f32 v128, v128
  v_exp_f32 v129, v129
  v_exp_f32 v130, v130
  v_exp_f32 v131, v131
  v_exp_f32 v132, v132
  v_exp_f32 v133, v133
  v_exp_f32 v134, v134
  v_exp_f32 v135, v135
  v_exp_f32 v136, v136
  v_exp_f32 v137, v137
  v_exp_f32 v138, v138
  v_exp_f32 v139, v139
  v_exp_f32 v140, v140
  v_exp_f32 v141, v141
  v_exp_f32 v142, v142
  v_exp_f32 v143, v143
  v_exp_f32 v144, v144
  v_exp_f32 v145, v145
  v_exp_f32 v146, v146
  v_exp_f32 v147, v147
  v_exp_f32 v148, v148
  v_exp_f32 v149, v149
  v_add_f32 v118, 1.0, v118
  v_add_f32 v119, 1.0, v119
  v_add_f32 v120, 1.0, v120
  v_add_f32 v121, 1.0, v121
  v_add_f32 v122, 1.0, v122
  v_add_f32 v123, 1.0, v123
  v_add_f32 v124, 1.0, v124
  v_add_f32 v125, 1.0, v125
  v_add_f32 v126, 1.0, v126
  v_add_f32 v127, 1.0, v127
  v_add_f32 v128, 1.0, v128
  v_add_f32 v129, 1.0, v129
  v_add_f32 v130, 1.0, v130
  v_add_f32 v131, 1.0, v131
  v_add_f32 v132, 1.0, v132
  v_add_f32 v133, 1.0, v133
  v_add_f32 v134, 1.0, v134
  v_add_f32 v135, 1.0, v135
  v_add_f32 v136, 1.0, v136
  v_add_f32 v137, 1.0, v137
  v_add_f32 v138, 1.0, v138
  v_add_f32 v139, 1.0, v139
  v_add_f32 v140, 1.0, v140
  v_add_f32 v141, 1.0, v141
  v_add_f32 v142, 1.0, v142
  v_add_f32 v143, 1.0, v143
  v_add_f32 v144, 1.0, v144
  v_add_f32 v145, 1.0, v145
  v_add_f32 v146, 1.0, v146
  v_add_f32 v147, 1.0, v147
  v_add_f32 v148, 1.0, v148
  v_add_f32 v149, 1.0, v149
  v_rcp_f32 v118, v118
  v_rcp_f32 v119, v119
  v_rcp_f32 v120, v120
  v_rcp_f32 v121, v121
  v_rcp_f32 v122, v122
  v_rcp_f32 v123, v123
  v_rcp_f32 v124, v124
  v_rcp_f32 v125, v125
  v_rcp_f32 v126, v126
  v_rcp_f32 v127, v127
  v_rcp_f32 v128, v128
  v_rcp_f32 v129, v129
  v_rcp_f32 v130, v130
  v_rcp_f32 v131, v131
  v_rcp_f32 v132, v132
  v_rcp_f32 v133, v133
  v_rcp_f32 v134, v134
  v_rcp_f32 v135, v135
  v_rcp_f32 v136, v136
  v_rcp_f32 v137, v137
  v_rcp_f32 v138, v138
  v_rcp_f32 v139, v139
  v_rcp_f32 v140, v140
  v_rcp_f32 v141, v141
  v_rcp_f32 v142, v142
  v_rcp_f32 v143, v143
  v_rcp_f32 v144, v144
  v_rcp_f32 v145, v145
  v_rcp_f32 v146, v146
  v_rcp_f32 v147, v147
  v_rcp_f32 v148, v148
  v_rcp_f32 v149, v149
  v_mul_f32 v118, v86, v118
  v_mul_f32 v119, v87, v119
  v_mul_f32 v120, v88, v120
  v_mul_f32 v121, v89, v121
  v_mul_f32 v122, v90, v122
  v_mul_f32 v123, v91, v123
  v_mul_f32 v124, v92, v124
  v_mul_f32 v125, v93, v125
  v_mul_f32 v126, v94, v126
  v_mul_f32 v127, v95, v127
  v_mul_f32 v128, v96, v128
  v_mul_f32 v129, v97, v129
  v_mul_f32 v130, v98, v130
  v_mul_f32 v131, v99, v131
  v_mul_f32 v132, v100, v132
  v_mul_f32 v133, v101, v133
  v_mul_f32 v134, v102, v134
  v_mul_f32 v135, v103, v135
  v_mul_f32 v136, v104, v136
  v_mul_f32 v137, v105, v137
  v_mul_f32 v138, v106, v138
  v_mul_f32 v139, v107, v139
  v_mul_f32 v140, v108, v140
  v_mul_f32 v141, v109, v141
  v_mul_f32 v142, v110, v142
  v_mul_f32 v143, v111, v143
  v_mul_f32 v144, v112, v144
  v_mul_f32 v145, v113, v145
  v_mul_f32 v146, v114, v146
  v_mul_f32 v147, v115, v147
  v_mul_f32 v148, v116, v148
  v_mul_f32 v149, v117, v149
  v_cvt_pk_bf16_f32 v150, v118, v119
  v_cvt_pk_bf16_f32 v151, v120, v121
  v_cvt_pk_bf16_f32 v152, v122, v123
  v_cvt_pk_bf16_f32 v153, v124, v125
  v_cvt_pk_bf16_f32 v154, v126, v127
  v_cvt_pk_bf16_f32 v155, v128, v129
  v_cvt_pk_bf16_f32 v156, v130, v131
  v_cvt_pk_bf16_f32 v157, v132, v133
  v_cvt_pk_bf16_f32 v158, v134, v135
  v_cvt_pk_bf16_f32 v159, v136, v137
  v_cvt_pk_bf16_f32 v160, v138, v139
  v_cvt_pk_bf16_f32 v161, v140, v141
  v_cvt_pk_bf16_f32 v162, v142, v143
  v_cvt_pk_bf16_f32 v163, v144, v145
  v_cvt_pk_bf16_f32 v164, v146, v147
  v_cvt_pk_bf16_f32 v165, v148, v149
  v_dot2_f32_bf16 v166, v150, v84, v166
  v_dot2_f32_bf16 v166, v151, v85, v166
  v_dot2_f32_bf16 v167, v152, v84, v167
  v_dot2_f32_bf16 v167, v153, v85, v167
  v_dot2_f32_bf16 v168, v154, v84, v168
  v_dot2_f32_bf16 v168, v155, v85, v168
  v_dot2_f32_bf16 v169, v156, v84, v169
  v_dot2_f32_bf16 v169, v157, v85, v169
  v_dot2_f32_bf16 v170, v158, v84, v170
  v_dot2_f32_bf16 v170, v159, v85, v170
  v_dot2_f32_bf16 v171, v160, v84, v171
  v_dot2_f32_bf16 v171, v161, v85, v171
  v_dot2_f32_bf16 v172, v162, v84, v172
  v_dot2_f32_bf16 v172, v163, v85, v172
  v_dot2_f32_bf16 v173, v164, v84, v173
  v_dot2_f32_bf16 v173, v165, v85, v173
  s_nop 2
  v_add_f32_dpp v166, v166, v166 quad_perm:[1,0,3,2] row_mask:0xf bank_mask:0xf
  v_add_f32_dpp v167, v167, v167 quad_perm:[1,0,3,2] row_mask:0xf bank_mask:0xf
  v_add_f32_dpp v168, v168, v168 quad_perm:[1,0,3,2] row_mask:0xf bank_mask:0xf
  v_add_f32_dpp v169, v169, v169 quad_perm:[1,0,3,2] row_mask:0xf bank_mask:0xf
  v_add_f32_dpp v170, v170, v170 quad_perm:[1,0,3,2] row_mask:0xf bank_mask:0xf
  v_add_f32_dpp v171, v171, v171 quad_perm:[1,0,3,2] row_mask:0xf bank_mask:0xf
  v_add_f32_dpp v172, v172, v172 quad_perm:[1,0,3,2] row_mask:0xf bank_mask:0xf
  v_add_f32_dpp v173, v173, v173 quad_perm:[1,0,3,2] row_mask:0xf bank_mask:0xf
  v_add_f32_dpp v166, v166, v166 quad_perm:[2,3,0,1] row_mask:0xf bank_mask:0xf
  v_add_f32_dpp v167, v167, v167 quad_perm:[2,3,0,1] row_mask:0xf bank_mask:0xf
  v_add_f32_dpp v168, v168, v168 quad_perm:[2,3,0,1] row_mask:0xf bank_mask:0xf
  v_add_f32_dpp v169, v169, v169 quad_perm:[2,3,0,1] row_mask:0xf bank_mask:0xf
  v_add_f32_dpp v170, v170, v170 quad_perm:[2,3,0,1] row_mask:0xf bank_mask:0xf
  v_add_f32_dpp v171, v171, v171 quad_perm:[2,3,0,1] row_mask:0xf bank_mask:0xf
  v_add_f32_dpp v172, v172, v172 quad_perm:[2,3,0,1] row_mask:0xf bank_mask:0xf
  v_add_f32_dpp v173, v173, v173 quad_perm:[2,3,0,1] row_mask:0xf bank_mask:0xf
  v_add_f32_dpp v166, v166, v166 row_half_mirror row_mask:0xf bank_mask:0xf
  v_add_f32_dpp v167, v167, v167 row_half_mirror row_mask:0xf bank_mask:0xf
  v_add_f32_dpp v168, v168, v168 row_half_mirror row_mask:0xf bank_mask:0xf
  v_add_f32_dpp v169, v169, v169 row_half_mirror row_mask:0xf bank_mask:0xf
  v_add_f32_dpp v170, v170, v170 row_half_mirror row_mask:0xf bank_mask:0xf
  v_add_f32_dpp v171, v171, v171 row_half_mirror row_mask:0xf bank_mask:0xf
  v_add_f32_dpp v172, v172, v172 row_half_mirror row_mask:0xf bank_mask:0xf
  v_add_f32_dpp v173, v173, v173 row_half_mirror row_mask:0xf bank_mask:0xf
  v_add_f32_dpp v166, v166, v166 row_mirror row_mask:0xf bank_mask:0xf
  v_add_f32_dpp v167, v167, v167 row_mirror row_mask:0xf bank_mask:0xf
  v_add_f32_dpp v168, v168, v168 row_mirror row_mask:0xf bank_mask:0xf
  v_add_f32_dpp v169, v169, v169 row_mirror row_mask:0xf bank_mask:0xf
  v_add_f32_dpp v170, v170, v170 row_mirror row_mask:0xf bank_mask:0xf
  v_add_f32_dpp v171, v171, v171 row_mirror row_mask:0xf bank_mask:0xf
  v_add_f32_dpp v172, v172, v172 row_mirror row_mask:0xf bank_mask:0xf
  v_add_f32_dpp v173, v173, v173 row_mirror row_mask:0xf bank_mask:0xf
  v_mov_b32 v150, v166
  v_mov_b32 v151, v167
  v_mov_b32 v152, v168
  v_mov_b32 v153, v169
  v_mov_b32 v154, v170
  v_mov_b32 v155, v171
  v_mov_b32 v156, v172
  v_mov_b32 v157, v173
  s_nop 1
  v_permlane16_swap_b32 v166, v150
  v_permlane16_swap_b32 v167, v151
  v_permlane16_swap_b32 v168, v152
  v_permlane16_swap_b32 v169, v153
  v_permlane16_swap_b32 v170, v154
  v_permlane16_swap_b32 v171, v155
  v_permlane16_swap_b32 v172, v156
  v_permlane16_swap_b32 v173, v157
  s_nop 0
  v_add_f32 v166, v166, v150
  v_add_f32 v167, v167, v151
  v_add_f32 v168, v168, v152
  v_add_f32 v169, v169, v153
  v_add_f32 v170, v170, v154
  v_add_f32 v171, v171, v155
  v_add_f32 v172, v172, v156
  v_add_f32 v173, v173, v157
  v_mov_b32 v150, v166
  v_mov_b32 v151, v167
  v_mov_b32 v152, v168
  v_mov_b32 v153, v169
  v_mov_b32 v154, v170
  v_mov_b32 v155, v171
  v_mov_b32 v156, v172
  v_mov_b32 v157, v173
  s_nop 1
  v_permlane32_swap_b32 v166, v150
  v_permlane32_swap_b32 v167, v151
  v_permlane32_swap_b32 v168, v152
  v_permlane32_swap_b32 v169, v153
  v_permlane32_swap_b32 v170, v154
  v_permlane32_swap_b32 v171, v155
  v_permlane32_swap_b32 v172, v156
  v_permlane32_swap_b32 v173, v157
  s_nop 0
  v_add_f32 v166, v166, v150
  v_add_f32 v167, v167, v151
  v_add_f32 v168, v168, v152
  v_add_f32 v169, v169, v153
  v_add_f32 v170, v170, v154
  v_add_f32 v171, v171, v155
  v_add_f32 v172, v172, v156
  v_add_f32 v173, v173, v157
  v_cvt_pk_bf16_f32 v166, v166, v166
  v_lshlrev_b32 v166, 16, v166
  v_cvt_pk_bf16_f32 v167, v167, v167
  v_lshlrev_b32 v167, 16, v167
  v_cvt_pk_bf16_f32 v168, v168, v168
  v_lshlrev_b32 v168, 16, v168
  v_cvt_pk_bf16_f32 v169, v169, v169
  v_lshlrev_b32 v169, 16, v169
  v_cvt_pk_bf16_f32 v170, v170, v170
  v_lshlrev_b32 v170, 16, v170
  v_cvt_pk_bf16_f32 v171, v171, v171
  v_lshlrev_b32 v171, 16, v171
  v_cvt_pk_bf16_f32 v172, v172, v172
  v_lshlrev_b32 v172, 16, v172
  v_cvt_pk_bf16_f32 v173, v173, v173
  v_lshlrev_b32 v173, 16, v173
  v_add_f32 v166, s59, v166
  v_add_f32 v167, s59, v167
  v_add_f32 v168, s59, v168
  v_add_f32 v169, s59, v169
  v_add_f32 v170, s59, v170
  v_add_f32 v171, s59, v171
  v_add_f32 v172, s59, v172
  v_add_f32 v173, s59, v173
  v_cvt_pk_bf16_f32 v166, v166, v166
  v_lshlrev_b32 v166, 16, v166
  v_cvt_pk_bf16_f32 v167, v167, v167
  v_lshlrev_b32 v167, 16, v167
  v_cvt_pk_bf16_f32 v168, v168, v168
  v_lshlrev_b32 v168, 16, v168
  v_cvt_pk_bf16_f32 v169, v169, v169
  v_lshlrev_b32 v169, 16, v169
  v_cvt_pk_bf16_f32 v170, v170, v170
  v_lshlrev_b32 v170, 16, v170
  v_cvt_pk_bf16_f32 v171, v171, v171
  v_lshlrev_b32 v171, 16, v171
  v_cvt_pk_bf16_f32 v172, v172, v172
  v_lshlrev_b32 v172, 16, v172
  v_cvt_pk_bf16_f32 v173, v173, v173
  v_lshlrev_b32 v173, 16, v173
  s_setprio 3
  v_mov_b32 v150, v166
  v_cmp_eq_u32 vcc, 1, v0
  s_nop 1
  v_cndmask_b32 v150, v150, v167, vcc
  v_cmp_eq_u32 vcc, 2, v0
  s_nop 1
  v_cndmask_b32 v150, v150, v168, vcc
  v_cmp_eq_u32 vcc, 3, v0
  s_nop 1
  v_cndmask_b32 v150, v150, v169, vcc
  v_cmp_eq_u32 vcc, 4, v0
  s_nop 1
  v_cndmask_b32 v150, v150, v170, vcc
  v_cmp_eq_u32 vcc, 5, v0
  s_nop 1
  v_cndmask_b32 v150, v150, v171, vcc
  v_cmp_eq_u32 vcc, 6, v0
  s_nop 1
  v_cndmask_b32 v150, v150, v172, vcc
  v_cmp_eq_u32 vcc, 7, v0
  s_nop 1
  v_cndmask_b32 v150, v150, v173, vcc
  v_mov_b32 v151, s58
  v_lshlrev_b32 v152, 11, v0
  s_lshl_b32 s92, s98, 3
  s_add_u32 s92, s92, 524288
  s_mov_b64 exec, 0xff
  buffer_store_dwordx2 v[150:151], v152, s[24:27], s92 offen sc1
  s_mov_b64 exec, -1
L_gskip:
  buffer_load_dwordx4 v225, s[20:23], s5 offen nt lds
  s_add_u32 s94, s57, 1024
  s_mov_b32 m0, s94
  s_add_u32 s5, s5, 32768
  buffer_load_dwordx4 v225, s[20:23], s5 offen nt lds
  s_add_u32 s94, s57, 2048
  s_mov_b32 m0, s94
  s_add_u32 s5, s5, 32768
  buffer_load_dwordx4 v225, s[20:23], s5 offen nt lds
  s_add_u32 s94, s57, 3072
  s_mov_b32 m0, s94
  s_add_u32 s5, s5, 32768
  buffer_load_dwordx4 v225, s[20:23], s5 offen nt lds
  s_waitcnt vmcnt(0)
  v_mov_b32 v208, 158940
  v_mov_b32 v209, 1
  s_waitcnt lgkmcnt(0)
  s_mov_b64 exec, 1
  ds_add_u32 v208, v209
  s_mov_b64 exec, -1
  v_lshrrev_b32 v210, 2, v12
  v_lshlrev_b32 v2, 10, v13
  v_lshl_add_u32 v2, v210, 7, v2
  v_and_b32 v210, 3, v12
  v_lshl_add_u32 v2, v210, 3, v2
  s_lshl_b32 s92, s3, 5
  s_add_u32 s92, s92, 131072
  v_add_u32 v2, s92, v2
  v_lshlrev_b32 v5, 11, v12
  v_and_b32 v208, 1, v12
  v_lshlrev_b32 v208, 10, v208
  v_sub_u32 v5, v5, v208
  v_lshl_add_u32 v5, v13, 4, v5
  s_lshl_b32 s72, s52, 15
  s_add_u32 s72, s72, 262144
  s_lshl_b32 s73, s53, 10
  s_add_u32 s73, s73, s72
  s_lshl_b32 s93, s3, 8
  s_add_u32 s73, s73, s93
  s_lshl_b32 s93, s55, 8
  s_add_u32 s72, s72, s93
  s_lshl_b32 s74, s52, 13
  s_lshl_b32 s93, s55, 11
  s_add_u32 s74, s74, s93
  s_lshl_b32 s93, s62, 8
  s_add_u32 s74, s74, s93
  s_lshl_b32 s93, s3, 6
  s_add_u32 s74, s74, s93
  s_add_u32 s74, s74, 2097152
  s_add_u32 s75, s74, 65536
  s_mov_b32 s6, 158720
  s_mov_b32 s7, 158848
  s_lshl_b32 s76, s52, 10
  s_lshl_b32 s93, s55, 3
  s_add_u32 s76, s76, s93
  s_add_u32 s76, s76, 131072
  s_lshr_b32 s93, s3, 1
  s_lshl_b32 s93, s93, 11
  s_add_u32 s71, s72, s93
  s_and_b32 s93, s3, 1
  s_lshl_b32 s93, s93, 7
  s_add_u32 s71, s71, s93
  s_lshl_b32 s93, s3, 11
  v_add_u32 v9, s93, v1
  s_lshl_b32 s93, s3, 9
  v_add_u32 v6, s93, v3
  v_add_u32 v11, 65536, v6
  v_lshlrev_b32 v7, 2, v0
  v_lshlrev_b32 v10, 17, v13
  v_lshl_add_u32 v10, v12, 2, v10
  s_cmp_eq_u32 s3, 0
  s_cbranch_scc0 L_notstat
  s_lshl_b32 s92, s52, 5
  s_add_u32 s92, s92, s53
  s_lshl_b32 s92, s92, 5
  s_add_u32 s92, s92, 131072
  v_lshl_add_u32 v219, v12, 3, s6
  v_lshl_add_u32 v228, v12, 2, s7
  v_mov_b32 v208, 158924
  s_mov_b32 s63, 800000
Lw_5:
  ds_read_b32 v209, v208
  s_waitcnt lgkmcnt(0)
  v_readfirstlane_b32 s99, v209
  s_nop 0
  s_cmp_ge_u32 s99, 4
  s_cbranch_scc1 Lwd_6
  s_sleep 1
  s_sub_u32 s63, s63, 1
  s_cbranch_scc0 Lw_5
Lwd_6:
  ds_read_b64 v[220:221], v219
  s_waitcnt lgkmcnt(0)
  v_mov_b32 v208, v220
  s_nop 1
  v_max_f32_dpp v208, v208, v208 row_ror:8 row_mask:0xf bank_mask:0xf
  s_nop 1
  v_max_f32_dpp v208, v208, v208 row_ror:4 row_mask:0xf bank_mask:0xf
  v_sub_f32 v210, v220, v208
  v_mul_f32 v210, s68, v210
  v_exp_f32 v210, v210
  s_nop 0
  v_mul_f32 v209, v210, v221
  s_nop 1
  v_add_f32_dpp v209, v209, v209 row_ror:8 row_mask:0xf bank_mask:0xf
  s_nop 1
  v_add_f32_dpp v209, v209, v209 row_ror:4 row_mask:0xf bank_mask:0xf
  v_rcp_f32 v211, v209
  s_nop 0
  v_mul_f32 v210, v210, v211
  ds_write_b32 v228, v210
  v_mov_b32 v216, 158928
  v_mov_b32 v217, 1
  s_waitcnt lgkmcnt(0)
  s_mov_b64 exec, 1
  ds_add_u32 v216, v217
  s_mov_b64 exec, -1
  v_min_u32 v208, -2, v208
  v_min_u32 v209, -2, v209
  s_mov_b64 exec, 15
  buffer_store_dwordx2 v[208:209], v3, s[24:27], s92 offen sc1
  s_mov_b64 exec, -1
  s_waitcnt vmcnt(0)
  v_mov_b32 v208, 158940
  s_mov_b32 s63, 800000
Lw_7:
  ds_read_b32 v209, v208
  s_waitcnt lgkmcnt(0)
  v_readfirstlane_b32 s99, v209
  s_nop 0
  s_cmp_ge_u32 s99, 4
  s_cbranch_scc1 Lwd_8
  s_sleep 2
  s_sub_u32 s63, s63, 1
  s_cbranch_scc0 Lw_7
Lwd_8:
  ds_read_b64_tr_b16 v[184:185], v2 offset:0
  ds_read_b64_tr_b16 v[186:187], v2 offset:512
  ds_read_b64_tr_b16 v[188:189], v2 offset:4096
  ds_read_b64_tr_b16 v[190:191], v2 offset:4608
  ds_read_b64_tr_b16 v[192:193], v2 offset:8192
  ds_read_b64_tr_b16 v[194:195], v2 offset:8704
  ds_read_b64_tr_b16 v[196:197], v2 offset:12288
  ds_read_b64_tr_b16 v[198:199], v2 offset:12800
  v_mov_b32 v208, 158936
  v_mov_b32 v209, 1
  s_waitcnt lgkmcnt(0)
  s_mov_b64 exec, 1
  ds_add_u32 v208, v209
  s_mov_b64 exec, -1
  s_branch L_pre_s4
L_notstat:
  v_mov_b32 v208, 158940
  s_mov_b32 s63, 800000
Lw_9:
  ds_read_b32 v209, v208
  s_waitcnt lgkmcnt(0)
  v_readfirstlane_b32 s99, v209
  s_nop 0
  s_cmp_ge_u32 s99, 4
  s_cbranch_scc1 Lwd_10
  s_sleep 2
  s_sub_u32 s63, s63, 1
  s_cbranch_scc0 Lw_9
Lwd_10:
  ds_read_b64_tr_b16 v[184:185], v2 offset:0
  ds_read_b64_tr_b16 v[186:187], v2 offset:512
  ds_read_b64_tr_b16 v[188:189], v2 offset:4096
  ds_read_b64_tr_b16 v[190:191], v2 offset:4608
  ds_read_b64_tr_b16 v[192:193], v2 offset:8192
  ds_read_b64_tr_b16 v[194:195], v2 offset:8704
  ds_read_b64_tr_b16 v[196:197], v2 offset:12288
  ds_read_b64_tr_b16 v[198:199], v2 offset:12800
  v_mov_b32 v208, 158936
  v_mov_b32 v209, 1
  s_waitcnt lgkmcnt(0)
  s_mov_b64 exec, 1
  ds_add_u32 v208, v209
  s_mov_b64 exec, -1
  s_cmp_lt_u32 s2, 8
  s_cbranch_scc0 L_pre_s4
  s_sub_u32 s92, s3, 1
  s_lshl_b32 s93, s92, 14
  s_add_u32 s93, s93, 524288
  s_add_u32 s94, s93, 4096
  s_add_u32 s95, s93, 8192
  s_add_u32 s96, s93, 12288
  v_and_b32 v218, 3, v0
  v_lshlrev_b32 v218, 6, v218
  s_lshl_b32 s92, s92, 13
  s_add_u32 s92, s92, 131072
  v_add_u32 v219, s92, v3
  v_mov_b32 v212, 158924
  s_mov_b32 s63, 800000
Lw_11:
  ds_read_b32 v213, v212
  s_waitcnt lgkmcnt(0)
  v_readfirstlane_b32 s99, v213
  s_nop 0
  s_cmp_ge_u32 s99, 1
  s_cbranch_scc1 Lwd_12
  s_sleep 4
  s_sub_u32 s63, s63, 1
  s_cbranch_scc0 Lw_11
Lwd_12:
  s_mov_b32 s63, 200000
L_gchk:
  buffer_load_dwordx4 v[86:89], v1, s[24:27], s93 offen offset:0 sc1
  buffer_load_dwordx4 v[90:93], v1, s[24:27], s93 offen offset:1024 sc1
  buffer_load_dwordx4 v[94:97], v1, s[24:27], s93 offen offset:2048 sc1
  buffer_load_dwordx4 v[98:101], v1, s[24:27], s93 offen offset:3072 sc1
  buffer_load_dwordx4 v[102:105], v1, s[24:27], s94 offen offset:0 sc1
  buffer_load_dwordx4 v[106:109], v1, s[24:27], s94 offen offset:1024 sc1
  buffer_load_dwordx4 v[110:113], v1, s[24:27], s94 offen offset:2048 sc1
  buffer_load_dwordx4 v[114:117], v1, s[24:27], s94 offen offset:3072 sc1
  buffer_load_dwordx4 v[118:121], v1, s[24:27], s95 offen offset:0 sc1
  buffer_load_dwordx4 v[122:125], v1, s[24:27], s95 offen offset:1024 sc1
  buffer_load_dwordx4 v[126:129], v1, s[24:27], s95 offen offset:2048 sc1
  buffer_load_dwordx4 v[130:133], v1, s[24:27], s95 offen offset:3072 sc1
  buffer_load_dwordx4 v[134:137], v1, s[24:27], s96 offen offset:0 sc1
  buffer_load_dwordx4 v[138:141], v1, s[24:27], s96 offen offset:1024 sc1
  buffer_load_dwordx4 v[142:145], v1, s[24:27], s96 offen offset:2048 sc1
  buffer_load_dwordx4 v[146:149], v1, s[24:27], s96 offen offset:3072 sc1
  buffer_load_dword v220, v218, s[32:35], 0 offen sc1
  buffer_load_dword v221, v218, s[32:35], 0 offen offset:32 sc1
  s_waitcnt vmcnt(0)
  v_and_b32 v208, v220, v221
  v_and_b32 v208, 1, v208
  v_xor_b32 v208, 1, v208
  v_xor_b32 v209, v220, v87
  v_xor_b32 v210, v221, v89
  v_or3_b32 v208, v208, v209, v210
  v_xor_b32 v209, v220, v91
  v_xor_b32 v210, v221, v93
  v_or3_b32 v208, v208, v209, v210
  v_xor_b32 v209, v220, v95
  v_xor_b32 v210, v221, v97
  v_or3_b32 v208, v208, v209, v210
  v_xor_b32 v209, v220, v99
  v_xor_b32 v210, v221, v101
  v_or3_b32 v208, v208, v209, v210
  v_xor_b32 v209, v220, v103
  v_xor_b32 v210, v221, v105
  v_or3_b32 v208, v208, v209, v210
  v_xor_b32 v209, v220, v107
  v_xor_b32 v210, v221, v109
  v_or3_b32 v208, v208, v209, v210
  v_xor_b32 v209, v220, v111
  v_xor_b32 v210, v221, v113
  v_or3_b32 v208, v208, v209, v210
  v_xor_b32 v209, v220, v115
  v_xor_b32 v210, v221, v117
  v_or3_b32 v208, v208, v209, v210
  v_xor_b32 v209, v220, v119
  v_xor_b32 v210, v221, v121
  v_or3_b32 v208, v208, v209, v210
  v_xor_b32 v209, v220, v123
  v_xor_b32 v210, v221, v125
  v_or3_b32 v208, v208, v209, v210
  v_xor_b32 v209, v220, v127
  v_xor_b32 v210, v221, v129
  v_or3_b32 v208, v208, v209, v210
  v_xor_b32 v209, v220, v131
  v_xor_b32 v210, v221, v133
  v_or3_b32 v208, v208, v209, v210
  v_xor_b32 v209, v220, v135
  v_xor_b32 v210, v221, v137
  v_or3_b32 v208, v208, v209, v210
  v_xor_b32 v209, v220, v139
  v_xor_b32 v210, v221, v141
  v_or3_b32 v208, v208, v209, v210
  v_xor_b32 v209, v220, v143
  v_xor_b32 v210, v221, v145
  v_or3_b32 v208, v208, v209, v210
  v_xor_b32 v209, v220, v147
  v_xor_b32 v210, v221, v149
  v_or3_b32 v208, v208, v209, v210
  v_cmp_ne_u32 vcc, 0, v208
  s_cbranch_vccz L_gok
  s_sleep 32
  s_sub_u32 s63, s63, 1
  s_cbranch_scc0 L_gchk
L_gok:
  v_mov_b32 v212, 158936
  s_mov_b32 s63, 800000
Lw_13:
  ds_read_b32 v213, v212
  s_waitcnt lgkmcnt(0)
  v_readfirstlane_b32 s99, v213
  s_nop 0
  s_cmp_ge_u32 s99, 4
  s_cbranch_scc1 Lwd_14
  s_sleep 1
  s_sub_u32 s63, s63, 1
  s_cbranch_scc0 Lw_13
Lwd_14:
  v_mov_b32 v87, v88
  v_mov_b32 v91, v92
  v_mov_b32 v95, v96
  v_mov_b32 v99, v100
  v_mov_b32 v103, v104
  v_mov_b32 v107, v108
  v_mov_b32 v111, v112
  v_mov_b32 v115, v116
  v_mov_b32 v119, v120
  v_mov_b32 v123, v124
  v_mov_b32 v127, v128
  v_mov_b32 v131, v132
  v_mov_b32 v135, v136
  v_mov_b32 v139, v140
  v_mov_b32 v143, v144
  v_mov_b32 v147, v148
  ds_write_b64 v219, v[86:87] offset:0
  ds_write_b64 v219, v[90:91] offset:512
  ds_write_b64 v219, v[94:95] offset:1024
  ds_write_b64 v219, v[98:99] offset:1536
  ds_write_b64 v219, v[102:103] offset:2048
  ds_write_b64 v219, v[106:107] offset:2560
  ds_write_b64 v219, v[110:111] offset:3072
  ds_write_b64 v219, v[114:115] offset:3584
  ds_write_b64 v219, v[118:119] offset:4096
  ds_write_b64 v219, v[122:123] offset:4608
  ds_write_b64 v219, v[126:127] offset:5120
  ds_write_b64 v219, v[130:131] offset:5632
  ds_write_b64 v219, v[134:135] offset:6144
  ds_write_b64 v219, v[138:139] offset:6656
  ds_write_b64 v219, v[142:143] offset:7168
  ds_write_b64 v219, v[146:147] offset:7680
L_pre_s4:
  s_waitcnt lgkmcnt(0)
  s_barrier
  ds_read_b64 v[86:87], v6 offset:0
  ds_read_b64 v[88:89], v6 offset:32768
  ds_read_b64 v[90:91], v11 offset:0
  ds_read_b64 v[92:93], v11 offset:32768
  s_mov_b64 s[80:81], -1
  s_mov_b64 s[82:83], -1
  s_mov_b64 s[84:85], -1
  s_mov_b64 s[86:87], -1
  s_mov_b32 s63, 200000
  s_waitcnt lgkmcnt(2)
  v_pk_add_f32 v[86:87], v[86:87], v[88:89]
  s_waitcnt lgkmcnt(0)
  v_pk_add_f32 v[90:91], v[90:91], v[92:93]
  v_pk_add_f32 v[86:87], v[86:87], v[90:91]
  v_cvt_pk_bf16_f32 v88, v86, v87
  v_min_u32 v88, -2, v88
  buffer_store_dword v88, v7, s[24:27], s73 offen sc1
  v_and_b32 v212, 31, v0
  v_lshlrev_b32 v213, 5, v212
  s_lshl_b32 s93, s3, 7
  s_add_u32 s93, s93, 20480
  v_lshl_add_u32 v214, v212, 2, s93
  v_lshl_add_u32 v215, v13, 5, s93
L_stloop:
  buffer_load_dwordx2 v[210:211], v213, s[24:27], s76 offen sc1
  s_waitcnt vmcnt(0)
L_stchk:
  v_max_u32 v208, v210, v211
  v_cmp_eq_u32 vcc, -1, v208
  s_cbranch_vccz L_stok
  s_sleep 20
  s_sub_u32 s63, s63, 1
  s_cbranch_scc0 L_stloop
L_stok:
  v_mov_b32 v208, v210
  s_nop 1
  v_max_f32_dpp v208, v208, v208 quad_perm:[1,0,3,2] row_mask:0xf bank_mask:0xf
  s_nop 1
  v_max_f32_dpp v208, v208, v208 quad_perm:[2,3,0,1] row_mask:0xf bank_mask:0xf
  v_sub_f32 v210, v210, v208
  v_mul_f32 v210, s68, v210
  v_exp_f32 v210, v210
  s_nop 0
  v_mul_f32 v210, v210, v211
  v_mov_b32 v209, v210
  s_nop 1
  v_add_f32_dpp v209, v209, v209 quad_perm:[1,0,3,2] row_mask:0xf bank_mask:0xf
  s_nop 1
  v_add_f32_dpp v209, v209, v209 quad_perm:[2,3,0,1] row_mask:0xf bank_mask:0xf
  v_rcp_f32 v209, v209
  s_nop 0
  v_mul_f32 v210, v210, v209
  ds_write_b32 v214, v210
  s_waitcnt lgkmcnt(0)
  ds_read_b128 v[160:163], v215
  ds_read_b128 v[164:167], v215 offset:16
L_wdone2:
  s_mov_b32 s63, 200000
L_r1loop:
  s_mov_b64 exec, s[80:81]
  buffer_load_dwordx4 v[128:131], v5, s[24:27], s71 offen sc1
  buffer_load_dwordx4 v[132:135], v5, s[24:27], s71 offen offset:64 sc1
  s_mov_b64 exec, -1
L_r1chk:
  s_waitcnt vmcnt(0)
  v_max3_u32 v208, v128, v129, v130
  v_max3_u32 v209, v131, v132, v133
  v_max3_u32 v208, v208, v134, v135
  v_max_u32 v208, v208, v209
  v_cmp_eq_u32 s[80:81], -1, v208
  s_cmp_eq_u64 s[80:81], 0
  s_cbranch_scc1 L_r1ok
  s_bcnt1_i32_b64 s92, s[80:81]
  s_cmp_le_u32 s92, 8
  s_cbranch_scc1 L_r1ns
  s_sleep 20
L_r1ns:
  s_sub_u32 s63, s63, 1
  s_cbranch_scc0 L_r1loop
L_r1ok:
  ds_write_b128 v9, v[128:131] offset:8192
  ds_write_b128 v9, v[132:135] offset:9216
  s_waitcnt lgkmcnt(0)
  s_barrier
  ds_read_b128 v[96:99], v1 offset:8192
  ds_read_b128 v[100:103], v1 offset:9216
  ds_read_b128 v[104:107], v1 offset:10240
  ds_read_b128 v[108:111], v1 offset:11264
  ds_read_b128 v[112:115], v1 offset:12288
  ds_read_b128 v[116:119], v1 offset:13312
  ds_read_b128 v[120:123], v1 offset:14336
  ds_read_b128 v[124:127], v1 offset:15360
  s_waitcnt lgkmcnt(0)
  v_mfma_f32_16x16x32_bf16 v[216:219], v[96:99], v[184:187], 0
  v_mfma_f32_16x16x32_bf16 v[220:223], v[112:115], v[184:187], 0
  v_mfma_f32_16x16x32_bf16 v[216:219], v[100:103], v[188:191], v[216:219]
  v_mfma_f32_16x16x32_bf16 v[220:223], v[116:119], v[188:191], v[220:223]
  v_mfma_f32_16x16x32_bf16 v[216:219], v[104:107], v[192:195], v[216:219]
  v_mfma_f32_16x16x32_bf16 v[220:223], v[120:123], v[192:195], v[220:223]
  v_mfma_f32_16x16x32_bf16 v[216:219], v[108:111], v[196:199], v[216:219]
  v_mfma_f32_16x16x32_bf16 v[220:223], v[124:127], v[196:199], v[220:223]
  s_nop 7
  v_mul_f32 v209, v160, v216
  v_mul_f32 v210, v164, v218
  v_fmac_f32 v209, v161, v217
  v_fmac_f32 v210, v165, v219
  v_fmac_f32 v209, v162, v220
  v_fmac_f32 v210, v166, v222
  v_fmac_f32 v209, v163, v221
  v_fmac_f32 v210, v167, v223
  v_min_u32 v209, -2, v209
  v_min_u32 v210, -2, v210
  buffer_store_dword v209, v10, s[24:27], s74 offen sc1
  buffer_store_dword v210, v10, s[24:27], s75 offen sc1
  s_cmp_lt_u32 s2, 8
  s_cbranch_scc0 L_fin
  s_lshl_b32 s92, s2, 16
  s_lshl_b32 s96, s3, 9
  s_add_u32 s92, s92, s96
  s_add_u32 s92, s92, 2097152
  s_add_u32 s96, s96, 161024
  v_lshl_add_u32 v192, v8, 1, s96
  v_lshlrev_b32 v193, 5, v0
  v_add_u32 v193, 161024, v193
  v_lshlrev_b32 v190, 16, v4
  v_and_b32 v191, 0xffff0000, v4
  v_and_b32 v194, 31, v0
  v_lshlrev_b32 v194, 4, v194
  v_lshrrev_b32 v195, 5, v0
  v_lshl_add_u32 v194, v195, 11, v194
  s_mov_b32 s63, 200000
  s_mov_b64 s[80:81], -1
  s_mov_b64 s[82:83], -1
  s_mov_b64 s[84:85], -1
  s_mov_b64 s[86:87], -1
  s_add_u32 s8, s92, 0
  s_add_u32 s9, s92, 4096
  s_add_u32 s10, s92, 8192
  s_add_u32 s11, s92, 12288
  s_add_u32 s12, s92, 16384
  s_add_u32 s13, s92, 20480
  s_add_u32 s14, s92, 24576
  s_add_u32 s15, s92, 28672
  s_add_u32 s16, s92, 32768
  s_add_u32 s17, s92, 36864
  s_add_u32 s18, s92, 40960
  s_add_u32 s19, s92, 45056
  s_add_u32 s20, s92, 49152
  s_add_u32 s21, s92, 53248
  s_add_u32 s22, s92, 57344
  s_add_u32 s23, s92, 61440
  s_waitcnt vmcnt(0)
L_r2loop:
  s_mov_b64 exec, s[80:81]
  buffer_load_dwordx4 v[96:99], v194, s[24:27], s8 offen sc1
  buffer_load_dwordx4 v[100:103], v194, s[24:27], s9 offen sc1
  buffer_load_dwordx4 v[104:107], v194, s[24:27], s10 offen sc1
  buffer_load_dwordx4 v[108:111], v194, s[24:27], s11 offen sc1
  s_mov_b64 exec, s[82:83]
  buffer_load_dwordx4 v[112:115], v194, s[24:27], s12 offen sc1
  buffer_load_dwordx4 v[116:119], v194, s[24:27], s13 offen sc1
  buffer_load_dwordx4 v[120:123], v194, s[24:27], s14 offen sc1
  buffer_load_dwordx4 v[124:127], v194, s[24:27], s15 offen sc1
  s_mov_b64 exec, s[84:85]
  buffer_load_dwordx4 v[128:131], v194, s[24:27], s16 offen sc1
  buffer_load_dwordx4 v[132:135], v194, s[24:27], s17 offen sc1
  buffer_load_dwordx4 v[136:139], v194, s[24:27], s18 offen sc1
  buffer_load_dwordx4 v[140:143], v194, s[24:27], s19 offen sc1
  s_mov_b64 exec, s[86:87]
  buffer_load_dwordx4 v[144:147], v194, s[24:27], s20 offen sc1
  buffer_load_dwordx4 v[148:151], v194, s[24:27], s21 offen sc1
  buffer_load_dwordx4 v[152:155], v194, s[24:27], s22 offen sc1
  buffer_load_dwordx4 v[156:159], v194, s[24:27], s23 offen sc1
  s_mov_b64 exec, -1
  s_waitcnt vmcnt(0)
  v_max3_u32 v208, v96, v97, v98
  v_max3_u32 v209, v112, v113, v114
  v_max3_u32 v210, v128, v129, v130
  v_max3_u32 v211, v144, v145, v146
  v_max3_u32 v208, v208, v99, v100
  v_max3_u32 v209, v209, v115, v116
  v_max3_u32 v210, v210, v131, v132
  v_max3_u32 v211, v211, v147, v148
  v_max3_u32 v208, v208, v101, v102
  v_max3_u32 v209, v209, v117, v118
  v_max3_u32 v210, v210, v133, v134
  v_max3_u32 v211, v211, v149, v150
  v_max3_u32 v208, v208, v103, v104
  v_max3_u32 v209, v209, v119, v120
  v_max3_u32 v210, v210, v135, v136
  v_max3_u32 v211, v211, v151, v152
  v_max3_u32 v208, v208, v105, v106
  v_max3_u32 v209, v209, v121, v122
  v_max3_u32 v210, v210, v137, v138
  v_max3_u32 v211, v211, v153, v154
  v_max3_u32 v208, v208, v107, v108
  v_max3_u32 v209, v209, v123, v124
  v_max3_u32 v210, v210, v139, v140
  v_max3_u32 v211, v211, v155, v156
  v_max3_u32 v208, v208, v109, v110
  v_max3_u32 v209, v209, v125, v126
  v_max3_u32 v210, v210, v141, v142
  v_max3_u32 v211, v211, v157, v158
  v_max_u32 v208, v208, v111
  v_max_u32 v209, v209, v127
  v_max_u32 v210, v210, v143
  v_max_u32 v211, v211, v159
  v_cmp_eq_u32 s[80:81], -1, v208
  v_cmp_eq_u32 s[82:83], -1, v209
  v_cmp_eq_u32 s[84:85], -1, v210
  v_cmp_eq_u32 s[86:87], -1, v211
  s_or_b64 s[90:91], s[80:81], s[82:83]
  s_or_b64 s[94:95], s[84:85], s[86:87]
  s_or_b64 s[90:91], s[90:91], s[94:95]
  s_cbranch_scc0 L_r2ok
  s_sub_u32 s63, s63, 1
  s_cbranch_scc0 L_r2loop
L_r2ok:
  v_pk_add_f32 v[216:217], v[96:97], v[100:101]
  v_pk_add_f32 v[218:219], v[98:99], v[102:103]
  v_pk_add_f32 v[220:221], v[112:113], v[116:117]
  v_pk_add_f32 v[222:223], v[114:115], v[118:119]
  v_pk_add_f32 v[224:225], v[128:129], v[132:133]
  v_pk_add_f32 v[226:227], v[130:131], v[134:135]
  v_pk_add_f32 v[228:229], v[144:145], v[148:149]
  v_pk_add_f32 v[230:231], v[146:147], v[150:151]
  v_pk_add_f32 v[216:217], v[216:217], v[104:105]
  v_pk_add_f32 v[218:219], v[218:219], v[106:107]
  v_pk_add_f32 v[220:221], v[220:221], v[120:121]
  v_pk_add_f32 v[222:223], v[222:223], v[122:123]
  v_pk_add_f32 v[224:225], v[224:225], v[136:137]
  v_pk_add_f32 v[226:227], v[226:227], v[138:139]
  v_pk_add_f32 v[228:229], v[228:229], v[152:153]
  v_pk_add_f32 v[230:231], v[230:231], v[154:155]
  v_pk_add_f32 v[216:217], v[216:217], v[108:109]
  v_pk_add_f32 v[218:219], v[218:219], v[110:111]
  v_pk_add_f32 v[220:221], v[220:221], v[124:125]
  v_pk_add_f32 v[222:223], v[222:223], v[126:127]
  v_pk_add_f32 v[224:225], v[224:225], v[140:141]
  v_pk_add_f32 v[226:227], v[226:227], v[142:143]
  v_pk_add_f32 v[228:229], v[228:229], v[156:157]
  v_pk_add_f32 v[230:231], v[230:231], v[158:159]
  v_pk_add_f32 v[216:217], v[216:217], v[220:221]
  v_pk_add_f32 v[224:225], v[224:225], v[228:229]
  v_pk_add_f32 v[218:219], v[218:219], v[222:223]
  v_pk_add_f32 v[226:227], v[226:227], v[230:231]
  v_pk_add_f32 v[216:217], v[216:217], v[224:225]
  v_pk_add_f32 v[218:219], v[218:219], v[226:227]
  s_nop 0
  v_permlane32_swap_b32 v216, v218
  v_permlane32_swap_b32 v217, v219
  s_nop 0
  v_pk_add_f32 v[220:221], v[216:217], v[218:219]
  v_cvt_pk_bf16_f32 v208, v220, v221
  v_lshlrev_b32 v220, 16, v208
  v_and_b32 v221, 0xffff0000, v208
  v_pk_add_f32 v[184:185], v[220:221], v[190:191]
  v_cvt_pk_bf16_f32 v208, v184, v185
  v_lshlrev_b32 v184, 16, v208
  v_and_b32 v185, 0xffff0000, v208
  ds_write_b64 v192, v[184:185]
  s_waitcnt lgkmcnt(0)
  s_barrier
  ds_read_b128 v[196:199], v193
  ds_read_b128 v[200:203], v193 offset:16
  s_waitcnt lgkmcnt(0)
  v_readfirstlane_b32 s97, v196
  s_nop 1
  v_mov_b32 v210, s97
  v_mov_b32 v211, s97
  v_pk_add_f32 v[212:213], v[196:197], v[210:211] neg_lo:[0,1] neg_hi:[0,1]
  v_pk_add_f32 v[214:215], v[198:199], v[210:211] neg_lo:[0,1] neg_hi:[0,1]
  v_pk_add_f32 v[216:217], v[200:201], v[210:211] neg_lo:[0,1] neg_hi:[0,1]
  v_pk_add_f32 v[218:219], v[202:203], v[210:211] neg_lo:[0,1] neg_hi:[0,1]
  v_pk_add_f32 v[208:209], v[212:213], v[214:215]
  v_pk_mul_f32 v[220:221], v[212:213], v[212:213]
  v_pk_add_f32 v[208:209], v[208:209], v[216:217]
  v_pk_fma_f32 v[220:221], v[214:215], v[214:215], v[220:221]
  v_pk_add_f32 v[208:209], v[208:209], v[218:219]
  v_pk_fma_f32 v[220:221], v[216:217], v[216:217], v[220:221]
  v_add_f32 v208, v208, v209
  v_pk_fma_f32 v[220:221], v[218:219], v[218:219], v[220:221]
  v_add_f32 v209, v220, v221
  s_nop 0
  v_add_f32_dpp v208, v208, v208 quad_perm:[1,0,3,2] row_mask:0xf bank_mask:0xf
  v_add_f32_dpp v209, v209, v209 quad_perm:[1,0,3,2] row_mask:0xf bank_mask:0xf
  s_nop 0
  v_add_f32_dpp v208, v208, v208 quad_perm:[2,3,0,1] row_mask:0xf bank_mask:0xf
  v_add_f32_dpp v209, v209, v209 quad_perm:[2,3,0,1] row_mask:0xf bank_mask:0xf
  s_nop 0
  v_add_f32_dpp v208, v208, v208 row_half_mirror row_mask:0xf bank_mask:0xf
  v_add_f32_dpp v209, v209, v209 row_half_mirror row_mask:0xf bank_mask:0xf
  s_nop 0
  v_add_f32_dpp v208, v208, v208 row_mirror row_mask:0xf bank_mask:0xf
  v_add_f32_dpp v209, v209, v209 row_mirror row_mask:0xf bank_mask:0xf
  v_mov_b32 v212, v208
  v_mov_b32 v213, v209
  s_nop 1
  v_permlane16_swap_b32 v208, v212
  v_permlane16_swap_b32 v209, v213
  s_nop 0
  v_add_f32 v208, v208, v212
  v_add_f32 v209, v209, v213
  v_mov_b32 v212, v208
  v_mov_b32 v213, v209
  s_nop 1
  v_permlane32_swap_b32 v208, v212
  v_permlane32_swap_b32 v209, v213
  s_nop 0
  v_add_f32 v208, v208, v212
  v_add_f32 v209, v209, v213
  v_mul_f32 v208, 0x3b000000, v208
  v_mul_f32 v209, 0x3b000000, v209
  v_fma_f32 v209, -v208, v208, v209
  v_add_f32 v208, v208, v210
  v_max_f32 v209, 0, v209
  v_cvt_pk_bf16_f32 v212, v208, v209
  v_lshlrev_b32 v208, 16, v212
  v_and_b32 v209, 0xffff0000, v212
  v_add_f32 v209, 0x3727c5ac, v209
  v_cvt_pk_bf16_f32 v209, v209, v209
  v_lshlrev_b32 v209, 16, v209
  v_sqrt_f32 v209, v209
  s_nop 0
  v_cvt_pk_bf16_f32 v209, v209, v209
  v_lshlrev_b32 v209, 16, v209
  v_rcp_f32 v210, v209
  v_mov_b32 v212, v208
  v_mov_b32 v213, v208
  v_mov_b32 v214, v209
  v_mov_b32 v215, v209
  v_mov_b32 v211, v210
  v_pk_add_f32 v[232:233], v[196:197], v[212:213] neg_lo:[0,1] neg_hi:[0,1]
  v_pk_add_f32 v[234:235], v[198:199], v[212:213] neg_lo:[0,1] neg_hi:[0,1]
  v_pk_add_f32 v[236:237], v[200:201], v[212:213] neg_lo:[0,1] neg_hi:[0,1]
  v_pk_add_f32 v[238:239], v[202:203], v[212:213] neg_lo:[0,1] neg_hi:[0,1]
  v_pk_add_f32 v[188:189], v[184:185], v[212:213] neg_lo:[0,1] neg_hi:[0,1]
  v_cvt_pk_bf16_f32 v216, v232, v233
  v_cvt_pk_bf16_f32 v217, v234, v235
  v_cvt_pk_bf16_f32 v218, v236, v237
  v_cvt_pk_bf16_f32 v219, v238, v239
  v_cvt_pk_bf16_f32 v220, v188, v189
  v_lshlrev_b32 v232, 16, v216
  v_and_b32 v233, 0xffff0000, v216
  v_lshlrev_b32 v234, 16, v217
  v_and_b32 v235, 0xffff0000, v217
  v_lshlrev_b32 v236, 16, v218
  v_and_b32 v237, 0xffff0000, v218
  v_lshlrev_b32 v238, 16, v219
  v_and_b32 v239, 0xffff0000, v219
  v_lshlrev_b32 v188, 16, v220
  v_and_b32 v189, 0xffff0000, v220
  v_pk_mul_f32 v[240:241], v[232:233], v[210:211]
  v_pk_mul_f32 v[242:243], v[234:235], v[210:211]
  v_pk_mul_f32 v[244:245], v[236:237], v[210:211]
  v_pk_mul_f32 v[246:247], v[238:239], v[210:211]
  v_pk_mul_f32 v[186:187], v[188:189], v[210:211]
  v_pk_fma_f32 v[232:233], v[240:241], v[214:215], v[232:233] neg_lo:[1,0,0] neg_hi:[1,0,0]
  v_pk_fma_f32 v[234:235], v[242:243], v[214:215], v[234:235] neg_lo:[1,0,0] neg_hi:[1,0,0]
  v_pk_fma_f32 v[236:237], v[244:245], v[214:215], v[236:237] neg_lo:[1,0,0] neg_hi:[1,0,0]
  v_pk_fma_f32 v[238:239], v[246:247], v[214:215], v[238:239] neg_lo:[1,0,0] neg_hi:[1,0,0]
  v_pk_fma_f32 v[188:189], v[186:187], v[214:215], v[188:189] neg_lo:[1,0,0] neg_hi:[1,0,0]
  v_pk_fma_f32 v[240:241], v[232:233], v[210:211], v[240:241]
  v_pk_fma_f32 v[242:243], v[234:235], v[210:211], v[242:243]
  v_pk_fma_f32 v[244:245], v[236:237], v[210:211], v[244:245]
  v_pk_fma_f32 v[246:247], v[238:239], v[210:211], v[246:247]
  v_pk_fma_f32 v[186:187], v[188:189], v[210:211], v[186:187]
  v_cvt_pk_bf16_f32 v216, v240, v241
  v_cvt_pk_bf16_f32 v217, v242, v243
  v_cvt_pk_bf16_f32 v218, v244, v245
  v_cvt_pk_bf16_f32 v219, v246, v247
  v_cvt_pk_bf16_f32 v220, v186, v187
  v_lshlrev_b32 v240, 16, v216
  v_and_b32 v241, 0xffff0000, v216
  v_lshlrev_b32 v242, 16, v217
  v_and_b32 v243, 0xffff0000, v217
  v_lshlrev_b32 v244, 16, v218
  v_and_b32 v245, 0xffff0000, v218
  v_lshlrev_b32 v246, 16, v219
  v_and_b32 v247, 0xffff0000, v219
  v_lshlrev_b32 v186, 16, v220
  v_and_b32 v187, 0xffff0000, v220
  v_readfirstlane_b32 s97, v240
  s_nop 1
  v_mov_b32 v210, s97
  v_mov_b32 v211, s97
  v_pk_add_f32 v[212:213], v[240:241], v[210:211] neg_lo:[0,1] neg_hi:[0,1]
  v_pk_add_f32 v[214:215], v[242:243], v[210:211] neg_lo:[0,1] neg_hi:[0,1]
  v_pk_add_f32 v[216:217], v[244:245], v[210:211] neg_lo:[0,1] neg_hi:[0,1]
  v_pk_add_f32 v[218:219], v[246:247], v[210:211] neg_lo:[0,1] neg_hi:[0,1]
  v_pk_add_f32 v[208:209], v[212:213], v[214:215]
  v_pk_mul_f32 v[220:221], v[212:213], v[212:213]
  v_pk_add_f32 v[208:209], v[208:209], v[216:217]
  v_pk_fma_f32 v[220:221], v[214:215], v[214:215], v[220:221]
  v_pk_add_f32 v[208:209], v[208:209], v[218:219]
  v_pk_fma_f32 v[220:221], v[216:217], v[216:217], v[220:221]
  v_add_f32 v208, v208, v209
  v_pk_fma_f32 v[220:221], v[218:219], v[218:219], v[220:221]
  v_add_f32 v209, v220, v221
  s_nop 0
  v_add_f32_dpp v208, v208, v208 quad_perm:[1,0,3,2] row_mask:0xf bank_mask:0xf
  v_add_f32_dpp v209, v209, v209 quad_perm:[1,0,3,2] row_mask:0xf bank_mask:0xf
  s_nop 0
  v_add_f32_dpp v208, v208, v208 quad_perm:[2,3,0,1] row_mask:0xf bank_mask:0xf
  v_add_f32_dpp v209, v209, v209 quad_perm:[2,3,0,1] row_mask:0xf bank_mask:0xf
  s_nop 0
  v_add_f32_dpp v208, v208, v208 row_half_mirror row_mask:0xf bank_mask:0xf
  v_add_f32_dpp v209, v209, v209 row_half_mirror row_mask:0xf bank_mask:0xf
  s_nop 0
  v_add_f32_dpp v208, v208, v208 row_mirror row_mask:0xf bank_mask:0xf
  v_add_f32_dpp v209, v209, v209 row_mirror row_mask:0xf bank_mask:0xf
  v_mov_b32 v212, v208
  v_mov_b32 v213, v209
  s_nop 1
  v_permlane16_swap_b32 v208, v212
  v_permlane16_swap_b32 v209, v213
  s_nop 0
  v_add_f32 v208, v208, v212
  v_add_f32 v209, v209, v213
  v_mov_b32 v212, v208
  v_mov_b32 v213, v209
  s_nop 1
  v_permlane32_swap_b32 v208, v212
  v_permlane32_swap_b32 v209, v213
  s_nop 0
  v_add_f32 v208, v208, v212
  v_add_f32 v209, v209, v213
  v_mul_f32 v208, 0x3b000000, v208
  v_mul_f32 v209, 0x3b000000, v209
  v_fma_f32 v209, -v208, v208, v209
  v_add_f32 v208, v208, v210
  v_max_f32 v209, 0, v209
  v_cvt_pk_bf16_f32 v212, v208, v209
  v_lshlrev_b32 v208, 16, v212
  v_and_b32 v209, 0xffff0000, v212
  v_add_f32 v209, 0x3727c5ac, v209
  v_cvt_pk_bf16_f32 v209, v209, v209
  v_lshlrev_b32 v209, 16, v209
  v_sqrt_f32 v209, v209
  s_nop 0
  v_cvt_pk_bf16_f32 v209, v209, v209
  v_lshlrev_b32 v209, 16, v209
  v_rcp_f32 v210, v209
  v_mov_b32 v212, v208
  v_mov_b32 v213, v208
  v_mov_b32 v214, v209
  v_mov_b32 v215, v209
  v_mov_b32 v211, v210
  v_pk_add_f32 v[188:189], v[186:187], v[212:213] neg_lo:[0,1] neg_hi:[0,1]
  v_cvt_pk_bf16_f32 v216, v188, v189
  v_lshlrev_b32 v188, 16, v216
  v_and_b32 v189, 0xffff0000, v216
  v_pk_mul_f32 v[186:187], v[188:189], v[210:211]
  v_pk_fma_f32 v[188:189], v[186:187], v[214:215], v[188:189] neg_lo:[1,0,0] neg_hi:[1,0,0]
  v_pk_fma_f32 v[186:187], v[188:189], v[210:211], v[186:187]
  v_cvt_pk_bf16_f32 v216, v186, v187
  v_lshlrev_b32 v186, 16, v216
  v_and_b32 v187, 0xffff0000, v216
  s_mov_b32 s98, 3072
  v_bfe_u32 v208, v186, 16, 15
  v_subrev_u32 v208, 13824, v208
  v_cmp_gt_u32 s[80:81], s98, v208
  v_lshrrev_b32 v209, 31, v186
  v_mul_u32_u24 v209, 3072, v209
  v_cndmask_b32 v208, 0, v208, s[80:81]
  v_add_lshl_u32 v208, v208, v209, 2
  v_add_u32 v208, 131072, v208
  ds_read_b32 v188, v208
  v_bfe_u32 v210, v187, 16, 15
  v_subrev_u32 v210, 13824, v210
  v_cmp_gt_u32 s[82:83], s98, v210
  v_lshrrev_b32 v211, 31, v187
  v_mul_u32_u24 v211, 3072, v211
  v_cndmask_b32 v210, 0, v210, s[82:83]
  v_add_lshl_u32 v210, v210, v211, 2
  v_add_u32 v210, 131072, v210
  ds_read_b32 v189, v210
  s_and_b64 s[94:95], s[80:81], s[82:83]
  s_lshl_b32 s92, s2, 10
  s_lshl_b32 s93, s3, 8
  s_add_u32 s92, s92, s93
  s_cmp_eq_u64 s[94:95], -1
  s_waitcnt lgkmcnt(0)
  s_cbranch_scc1 L_nofb
  s_waitcnt vmcnt(0)
  buffer_load_dwordx4 v[86:89], v1, s[40:43], 0 offen offset:0
  buffer_load_dwordx4 v[90:93], v1, s[40:43], 0 offen offset:1024
  buffer_load_dwordx4 v[94:97], v1, s[40:43], 0 offen offset:2048
  buffer_load_dwordx2 v[98:99], v3, s[40:43], 0 offen offset:3072
  buffer_load_dwordx4 v[100:103], v1, s[44:47], 0 offen offset:0
  buffer_load_dwordx4 v[104:107], v1, s[44:47], 0 offen offset:1024
  buffer_load_dwordx4 v[108:111], v1, s[44:47], 0 offen offset:2048
  buffer_load_dwordx2 v[112:113], v3, s[44:47], 0 offen offset:3072
  buffer_load_dwordx4 v[72:75], v1, s[48:51], 0 offen offset:0
  buffer_load_dwordx4 v[76:79], v1, s[48:51], 0 offen offset:1024
  buffer_load_dwordx4 v[80:83], v1, s[48:51], 0 offen offset:2048
  buffer_load_dwordx2 v[84:85], v3, s[48:51], 0 offen offset:3072
  s_waitcnt vmcnt(0)
  v_lshlrev_b32 v16, 16, v86
  v_and_b32 v17, 0xffff0000, v86
  v_lshlrev_b32 v18, 16, v87
  v_and_b32 v19, 0xffff0000, v87
  v_lshlrev_b32 v20, 16, v88
  v_and_b32 v21, 0xffff0000, v88
  v_lshlrev_b32 v22, 16, v89
  v_and_b32 v23, 0xffff0000, v89
  v_lshlrev_b32 v24, 16, v90
  v_and_b32 v25, 0xffff0000, v90
  v_lshlrev_b32 v26, 16, v91
  v_and_b32 v27, 0xffff0000, v91
  v_lshlrev_b32 v28, 16, v92
  v_and_b32 v29, 0xffff0000, v92
  v_lshlrev_b32 v30, 16, v93
  v_and_b32 v31, 0xffff0000, v93
  v_lshlrev_b32 v32, 16, v94
  v_and_b32 v33, 0xffff0000, v94
  v_lshlrev_b32 v34, 16, v95
  v_and_b32 v35, 0xffff0000, v95
  v_lshlrev_b32 v36, 16, v96
  v_and_b32 v37, 0xffff0000, v96
  v_lshlrev_b32 v38, 16, v97
  v_and_b32 v39, 0xffff0000, v97
  v_lshlrev_b32 v40, 16, v98
  v_and_b32 v41, 0xffff0000, v98
  v_lshlrev_b32 v42, 16, v99
  v_and_b32 v43, 0xffff0000, v99
  v_lshlrev_b32 v44, 16, v100
  v_and_b32 v45, 0xffff0000, v100
  v_lshlrev_b32 v46, 16, v101
  v_and_b32 v47, 0xffff0000, v101
  v_lshlrev_b32 v48, 16, v102
  v_and_b32 v49, 0xffff0000, v102
  v_lshlrev_b32 v50, 16, v103
  v_and_b32 v51, 0xffff0000, v103
  v_lshlrev_b32 v52, 16, v104
  v_and_b32 v53, 0xffff0000, v104
  v_lshlrev_b32 v54, 16, v105
  v_and_b32 v55, 0xffff0000, v105
  v_lshlrev_b32 v56, 16, v106
  v_and_b32 v57, 0xffff0000, v106
  v_lshlrev_b32 v58, 16, v107
  v_and_b32 v59, 0xffff0000, v107
  v_lshlrev_b32 v60, 16, v108
  v_and_b32 v61, 0xffff0000, v108
  v_lshlrev_b32 v62, 16, v109
  v_and_b32 v63, 0xffff0000, v109
  v_lshlrev_b32 v64, 16, v110
  v_and_b32 v65, 0xffff0000, v110
  v_lshlrev_b32 v66, 16, v111
  v_and_b32 v67, 0xffff0000, v111
  v_lshlrev_b32 v68, 16, v112
  v_and_b32 v69, 0xffff0000, v112
  v_lshlrev_b32 v70, 16, v113
  v_and_b32 v71, 0xffff0000, v113
  v_mov_b32 v182, 0xc0135761
  s_not_b64 s[94:95], s[80:81]
Lfb_15:
  s_cmp_eq_u64 s[94:95], 0
  s_cbranch_scc1 Lfbd_16
  s_ff1_i32_b64 s96, s[94:95]
  s_bitset0_b64 s[94:95], s96
  v_readlane_b32 s97, v186, s96
  v_mov_b32 v166, 0
  s_nop 1
  v_mov_b32 v174, s97
  v_mov_b32 v182, 0xc0135761
  v_mul_f32 v86, v174, v16
  v_mul_f32 v87, v174, v17
  v_mul_f32 v88, v174, v18
  v_mul_f32 v89, v174, v19
  v_cvt_pk_bf16_f32 v150, v86, v87
  v_cvt_pk_bf16_f32 v151, v88, v89
  v_dot2_f32_bf16 v86, v150, s69, v44
  v_dot2_f32_bf16 v87, v150, s70, v45
  v_dot2_f32_bf16 v88, v151, s69, v46
  v_dot2_f32_bf16 v89, v151, s70, v47
  s_nop 0
  v_cvt_pk_bf16_f32 v150, v86, v87
  s_nop 1
  v_cvt_pk_bf16_f32 v151, v88, v89
  v_lshlrev_b32 v86, 16, v150
  v_and_b32 v87, 0xffff0000, v150
  v_lshlrev_b32 v88, 16, v151
  v_and_b32 v89, 0xffff0000, v151
  v_mul_f32 v118, v86, v86
  v_mul_f32 v119, v87, v87
  v_mul_f32 v120, v88, v88
  v_mul_f32 v121, v89, v89
  v_fmamk_f32 v118, v118, 0xbdd2d3e8, v182
  v_fmamk_f32 v119, v119, 0xbdd2d3e8, v182
  v_fmamk_f32 v120, v120, 0xbdd2d3e8, v182
  v_fmamk_f32 v121, v121, 0xbdd2d3e8, v182
  v_mul_f32 v118, v86, v118
  v_mul_f32 v119, v87, v119
  v_mul_f32 v120, v88, v120
  v_mul_f32 v121, v89, v121
  v_exp_f32 v118, v118
  v_exp_f32 v119, v119
  v_exp_f32 v120, v120
  v_exp_f32 v121, v121
  v_add_f32 v118, 1.0, v118
  v_add_f32 v119, 1.0, v119
  v_add_f32 v120, 1.0, v120
  v_add_f32 v121, 1.0, v121
  v_rcp_f32 v118, v118
  v_rcp_f32 v119, v119
  v_rcp_f32 v120, v120
  v_rcp_f32 v121, v121
  v_mul_f32 v118, v86, v118
  v_mul_f32 v119, v87, v119
  v_mul_f32 v120, v88, v120
  v_mul_f32 v121, v89, v121
  v_cvt_pk_bf16_f32 v150, v118, v119
  v_cvt_pk_bf16_f32 v151, v120, v121
  v_dot2_f32_bf16 v166, v150, v72, v166
  v_dot2_f32_bf16 v166, v151, v73, v166
  s_nop 2
  v_mul_f32 v86, v174, v20
  v_mul_f32 v87, v174, v21
  v_mul_f32 v88, v174, v22
  v_mul_f32 v89, v174, v23
  v_cvt_pk_bf16_f32 v150, v86, v87
  v_cvt_pk_bf16_f32 v151, v88, v89
  v_dot2_f32_bf16 v86, v150, s69, v48
  v_dot2_f32_bf16 v87, v150, s70, v49
  v_dot2_f32_bf16 v88, v151, s69, v50
  v_dot2_f32_bf16 v89, v151, s70, v51
  s_nop 0
  v_cvt_pk_bf16_f32 v150, v86, v87
  s_nop 1
  v_cvt_pk_bf16_f32 v151, v88, v89
  v_lshlrev_b32 v86, 16, v150
  v_and_b32 v87, 0xffff0000, v150
  v_lshlrev_b32 v88, 16, v151
  v_and_b32 v89, 0xffff0000, v151
  v_mul_f32 v118, v86, v86
  v_mul_f32 v119, v87, v87
  v_mul_f32 v120, v88, v88
  v_mul_f32 v121, v89, v89
  v_fmamk_f32 v118, v118, 0xbdd2d3e8, v182
  v_fmamk_f32 v119, v119, 0xbdd2d3e8, v182
  v_fmamk_f32 v120, v120, 0xbdd2d3e8, v182
  v_fmamk_f32 v121, v121, 0xbdd2d3e8, v182
  v_mul_f32 v118, v86, v118
  v_mul_f32 v119, v87, v119
  v_mul_f32 v120, v88, v120
  v_mul_f32 v121, v89, v121
  v_exp_f32 v118, v118
  v_exp_f32 v119, v119
  v_exp_f32 v120, v120
  v_exp_f32 v121, v121
  v_add_f32 v118, 1.0, v118
  v_add_f32 v119, 1.0, v119
  v_add_f32 v120, 1.0, v120
  v_add_f32 v121, 1.0, v121
  v_rcp_f32 v118, v118
  v_rcp_f32 v119, v119
  v_rcp_f32 v120, v120
  v_rcp_f32 v121, v121
  v_mul_f32 v118, v86, v118
  v_mul_f32 v119, v87, v119
  v_mul_f32 v120, v88, v120
  v_mul_f32 v121, v89, v121
  v_cvt_pk_bf16_f32 v150, v118, v119
  v_cvt_pk_bf16_f32 v151, v120, v121
  v_dot2_f32_bf16 v166, v150, v74, v166
  v_dot2_f32_bf16 v166, v151, v75, v166
  s_nop 2
  v_mul_f32 v86, v174, v24
  v_mul_f32 v87, v174, v25
  v_mul_f32 v88, v174, v26
  v_mul_f32 v89, v174, v27
  v_cvt_pk_bf16_f32 v150, v86, v87
  v_cvt_pk_bf16_f32 v151, v88, v89
  v_dot2_f32_bf16 v86, v150, s69, v52
  v_dot2_f32_bf16 v87, v150, s70, v53
  v_dot2_f32_bf16 v88, v151, s69, v54
  v_dot2_f32_bf16 v89, v151, s70, v55
  s_nop 0
  v_cvt_pk_bf16_f32 v150, v86, v87
  s_nop 1
  v_cvt_pk_bf16_f32 v151, v88, v89
  v_lshlrev_b32 v86, 16, v150
  v_and_b32 v87, 0xffff0000, v150
  v_lshlrev_b32 v88, 16, v151
  v_and_b32 v89, 0xffff0000, v151
  v_mul_f32 v118, v86, v86
  v_mul_f32 v119, v87, v87
  v_mul_f32 v120, v88, v88
  v_mul_f32 v121, v89, v89
  v_fmamk_f32 v118, v118, 0xbdd2d3e8, v182
  v_fmamk_f32 v119, v119, 0xbdd2d3e8, v182
  v_fmamk_f32 v120, v120, 0xbdd2d3e8, v182
  v_fmamk_f32 v121, v121, 0xbdd2d3e8, v182
  v_mul_f32 v118, v86, v118
  v_mul_f32 v119, v87, v119
  v_mul_f32 v120, v88, v120
  v_mul_f32 v121, v89, v121
  v_exp_f32 v118, v118
  v_exp_f32 v119, v119
  v_exp_f32 v120, v120
  v_exp_f32 v121, v121
  v_add_f32 v118, 1.0, v118
  v_add_f32 v119, 1.0, v119
  v_add_f32 v120, 1.0, v120
  v_add_f32 v121, 1.0, v121
  v_rcp_f32 v118, v118
  v_rcp_f32 v119, v119
  v_rcp_f32 v120, v120
  v_rcp_f32 v121, v121
  v_mul_f32 v118, v86, v118
  v_mul_f32 v119, v87, v119
  v_mul_f32 v120, v88, v120
  v_mul_f32 v121, v89, v121
  v_cvt_pk_bf16_f32 v150, v118, v119
  v_cvt_pk_bf16_f32 v151, v120, v121
  v_dot2_f32_bf16 v166, v150, v76, v166
  v_dot2_f32_bf16 v166, v151, v77, v166
  s_nop 2
  v_mul_f32 v86, v174, v28
  v_mul_f32 v87, v174, v29
  v_mul_f32 v88, v174, v30
  v_mul_f32 v89, v174, v31
  v_cvt_pk_bf16_f32 v150, v86, v87
  v_cvt_pk_bf16_f32 v151, v88, v89
  v_dot2_f32_bf16 v86, v150, s69, v56
  v_dot2_f32_bf16 v87, v150, s70, v57
  v_dot2_f32_bf16 v88, v151, s69, v58
  v_dot2_f32_bf16 v89, v151, s70, v59
  s_nop 0
  v_cvt_pk_bf16_f32 v150, v86, v87
  s_nop 1
  v_cvt_pk_bf16_f32 v151, v88, v89
  v_lshlrev_b32 v86, 16, v150
  v_and_b32 v87, 0xffff0000, v150
  v_lshlrev_b32 v88, 16, v151
  v_and_b32 v89, 0xffff0000, v151
  v_mul_f32 v118, v86, v86
  v_mul_f32 v119, v87, v87
  v_mul_f32 v120, v88, v88
  v_mul_f32 v121, v89, v89
  v_fmamk_f32 v118, v118, 0xbdd2d3e8, v182
  v_fmamk_f32 v119, v119, 0xbdd2d3e8, v182
  v_fmamk_f32 v120, v120, 0xbdd2d3e8, v182
  v_fmamk_f32 v121, v121, 0xbdd2d3e8, v182
  v_mul_f32 v118, v86, v118
  v_mul_f32 v119, v87, v119
  v_mul_f32 v120, v88, v120
  v_mul_f32 v121, v89, v121
  v_exp_f32 v118, v118
  v_exp_f32 v119, v119
  v_exp_f32 v120, v120
  v_exp_f32 v121, v121
  v_add_f32 v118, 1.0, v118
  v_add_f32 v119, 1.0, v119
  v_add_f32 v120, 1.0, v120
  v_add_f32 v121, 1.0, v121
  v_rcp_f32 v118, v118
  v_rcp_f32 v119, v119
  v_rcp_f32 v120, v120
  v_rcp_f32 v121, v121
  v_mul_f32 v118, v86, v118
  v_mul_f32 v119, v87, v119
  v_mul_f32 v120, v88, v120
  v_mul_f32 v121, v89, v121
  v_cvt_pk_bf16_f32 v150, v118, v119
  v_cvt_pk_bf16_f32 v151, v120, v121
  v_dot2_f32_bf16 v166, v150, v78, v166
  v_dot2_f32_bf16 v166, v151, v79, v166
  s_nop 2
  v_mul_f32 v86, v174, v32
  v_mul_f32 v87, v174, v33
  v_mul_f32 v88, v174, v34
  v_mul_f32 v89, v174, v35
  v_cvt_pk_bf16_f32 v150, v86, v87
  v_cvt_pk_bf16_f32 v151, v88, v89
  v_dot2_f32_bf16 v86, v150, s69, v60
  v_dot2_f32_bf16 v87, v150, s70, v61
  v_dot2_f32_bf16 v88, v151, s69, v62
  v_dot2_f32_bf16 v89, v151, s70, v63
  s_nop 0
  v_cvt_pk_bf16_f32 v150, v86, v87
  s_nop 1
  v_cvt_pk_bf16_f32 v151, v88, v89
  v_lshlrev_b32 v86, 16, v150
  v_and_b32 v87, 0xffff0000, v150
  v_lshlrev_b32 v88, 16, v151
  v_and_b32 v89, 0xffff0000, v151
  v_mul_f32 v118, v86, v86
  v_mul_f32 v119, v87, v87
  v_mul_f32 v120, v88, v88
  v_mul_f32 v121, v89, v89
  v_fmamk_f32 v118, v118, 0xbdd2d3e8, v182
  v_fmamk_f32 v119, v119, 0xbdd2d3e8, v182
  v_fmamk_f32 v120, v120, 0xbdd2d3e8, v182
  v_fmamk_f32 v121, v121, 0xbdd2d3e8, v182
  v_mul_f32 v118, v86, v118
  v_mul_f32 v119, v87, v119
  v_mul_f32 v120, v88, v120
  v_mul_f32 v121, v89, v121
  v_exp_f32 v118, v118
  v_exp_f32 v119, v119
  v_exp_f32 v120, v120
  v_exp_f32 v121, v121
  v_add_f32 v118, 1.0, v118
  v_add_f32 v119, 1.0, v119
  v_add_f32 v120, 1.0, v120
  v_add_f32 v121, 1.0, v121
  v_rcp_f32 v118, v118
  v_rcp_f32 v119, v119
  v_rcp_f32 v120, v120
  v_rcp_f32 v121, v121
  v_mul_f32 v118, v86, v118
  v_mul_f32 v119, v87, v119
  v_mul_f32 v120, v88, v120
  v_mul_f32 v121, v89, v121
  v_cvt_pk_bf16_f32 v150, v118, v119
  v_cvt_pk_bf16_f32 v151, v120, v121
  v_dot2_f32_bf16 v166, v150, v80, v166
  v_dot2_f32_bf16 v166, v151, v81, v166
  s_nop 2
  v_mul_f32 v86, v174, v36
  v_mul_f32 v87, v174, v37
  v_mul_f32 v88, v174, v38
  v_mul_f32 v89, v174, v39
  v_cvt_pk_bf16_f32 v150, v86, v87
  v_cvt_pk_bf16_f32 v151, v88, v89
  v_dot2_f32_bf16 v86, v150, s69, v64
  v_dot2_f32_bf16 v87, v150, s70, v65
  v_dot2_f32_bf16 v88, v151, s69, v66
  v_dot2_f32_bf16 v89, v151, s70, v67
  s_nop 0
  v_cvt_pk_bf16_f32 v150, v86, v87
  s_nop 1
  v_cvt_pk_bf16_f32 v151, v88, v89
  v_lshlrev_b32 v86, 16, v150
  v_and_b32 v87, 0xffff0000, v150
  v_lshlrev_b32 v88, 16, v151
  v_and_b32 v89, 0xffff0000, v151
  v_mul_f32 v118, v86, v86
  v_mul_f32 v119, v87, v87
  v_mul_f32 v120, v88, v88
  v_mul_f32 v121, v89, v89
  v_fmamk_f32 v118, v118, 0xbdd2d3e8, v182
  v_fmamk_f32 v119, v119, 0xbdd2d3e8, v182
  v_fmamk_f32 v120, v120, 0xbdd2d3e8, v182
  v_fmamk_f32 v121, v121, 0xbdd2d3e8, v182
  v_mul_f32 v118, v86, v118
  v_mul_f32 v119, v87, v119
  v_mul_f32 v120, v88, v120
  v_mul_f32 v121, v89, v121
  v_exp_f32 v118, v118
  v_exp_f32 v119, v119
  v_exp_f32 v120, v120
  v_exp_f32 v121, v121
  v_add_f32 v118, 1.0, v118
  v_add_f32 v119, 1.0, v119
  v_add_f32 v120, 1.0, v120
  v_add_f32 v121, 1.0, v121
  v_rcp_f32 v118, v118
  v_rcp_f32 v119, v119
  v_rcp_f32 v120, v120
  v_rcp_f32 v121, v121
  v_mul_f32 v118, v86, v118
  v_mul_f32 v119, v87, v119
  v_mul_f32 v120, v88, v120
  v_mul_f32 v121, v89, v121
  v_cvt_pk_bf16_f32 v150, v118, v119
  v_cvt_pk_bf16_f32 v151, v120, v121
  v_dot2_f32_bf16 v166, v150, v82, v166
  v_dot2_f32_bf16 v166, v151, v83, v166
  s_nop 2
  v_mul_f32 v86, v174, v40
  v_mul_f32 v87, v174, v41
  v_mul_f32 v88, v174, v42
  v_mul_f32 v89, v174, v43
  v_cvt_pk_bf16_f32 v150, v86, v87
  v_cvt_pk_bf16_f32 v151, v88, v89
  v_dot2_f32_bf16 v86, v150, s69, v68
  v_dot2_f32_bf16 v87, v150, s70, v69
  v_dot2_f32_bf16 v88, v151, s69, v70
  v_dot2_f32_bf16 v89, v151, s70, v71
  s_nop 0
  v_cvt_pk_bf16_f32 v150, v86, v87
  s_nop 1
  v_cvt_pk_bf16_f32 v151, v88, v89
  v_lshlrev_b32 v86, 16, v150
  v_and_b32 v87, 0xffff0000, v150
  v_lshlrev_b32 v88, 16, v151
  v_and_b32 v89, 0xffff0000, v151
  v_mul_f32 v118, v86, v86
  v_mul_f32 v119, v87, v87
  v_mul_f32 v120, v88, v88
  v_mul_f32 v121, v89, v89
  v_fmamk_f32 v118, v118, 0xbdd2d3e8, v182
  v_fmamk_f32 v119, v119, 0xbdd2d3e8, v182
  v_fmamk_f32 v120, v120, 0xbdd2d3e8, v182
  v_fmamk_f32 v121, v121, 0xbdd2d3e8, v182
  v_mul_f32 v118, v86, v118
  v_mul_f32 v119, v87, v119
  v_mul_f32 v120, v88, v120
  v_mul_f32 v121, v89, v121
  v_exp_f32 v118, v118
  v_exp_f32 v119, v119
  v_exp_f32 v120, v120
  v_exp_f32 v121, v121
  v_add_f32 v118, 1.0, v118
  v_add_f32 v119, 1.0, v119
  v_add_f32 v120, 1.0, v120
  v_add_f32 v121, 1.0, v121
  v_rcp_f32 v118, v118
  v_rcp_f32 v119, v119
  v_rcp_f32 v120, v120
  v_rcp_f32 v121, v121
  v_mul_f32 v118, v86, v118
  v_mul_f32 v119, v87, v119
  v_mul_f32 v120, v88, v120
  v_mul_f32 v121, v89, v121
  v_cvt_pk_bf16_f32 v150, v118, v119
  v_cvt_pk_bf16_f32 v151, v120, v121
  v_dot2_f32_bf16 v166, v150, v84, v166
  v_dot2_f32_bf16 v166, v151, v85, v166
  s_nop 2
  s_nop 1
  v_add_f32_dpp v166, v166, v166 quad_perm:[1,0,3,2] row_mask:0xf bank_mask:0xf
  s_nop 1
  v_add_f32_dpp v166, v166, v166 quad_perm:[2,3,0,1] row_mask:0xf bank_mask:0xf
  s_nop 1
  v_add_f32_dpp v166, v166, v166 row_half_mirror row_mask:0xf bank_mask:0xf
  s_nop 1
  v_add_f32_dpp v166, v166, v166 row_mirror row_mask:0xf bank_mask:0xf
  v_mov_b32 v150, v166
  s_nop 1
  v_permlane16_swap_b32 v166, v150
  s_nop 0
  v_add_f32 v166, v166, v150
  v_mov_b32 v150, v166
  s_nop 1
  v_permlane32_swap_b32 v166, v150
  s_nop 0
  v_add_f32 v166, v166, v150
  v_cvt_pk_bf16_f32 v166, v166, v166
  v_lshlrev_b32 v166, 16, v166
  v_add_f32 v166, s59, v166
  v_cvt_pk_bf16_f32 v166, v166, v166
  v_lshlrev_b32 v166, 16, v166
  s_lshl_b64 exec, 1, s96
  v_mov_b32 v188, v166
  s_mov_b64 exec, -1
  s_branch Lfb_15
Lfbd_16:
  s_not_b64 s[94:95], s[82:83]
Lfb_17:
  s_cmp_eq_u64 s[94:95], 0
  s_cbranch_scc1 Lfbd_18
  s_ff1_i32_b64 s96, s[94:95]
  s_bitset0_b64 s[94:95], s96
  v_readlane_b32 s97, v187, s96
  v_mov_b32 v166, 0
  s_nop 1
  v_mov_b32 v174, s97
  v_mov_b32 v182, 0xc0135761
  v_mul_f32 v86, v174, v16
  v_mul_f32 v87, v174, v17
  v_mul_f32 v88, v174, v18
  v_mul_f32 v89, v174, v19
  v_cvt_pk_bf16_f32 v150, v86, v87
  v_cvt_pk_bf16_f32 v151, v88, v89
  v_dot2_f32_bf16 v86, v150, s69, v44
  v_dot2_f32_bf16 v87, v150, s70, v45
  v_dot2_f32_bf16 v88, v151, s69, v46
  v_dot2_f32_bf16 v89, v151, s70, v47
  s_nop 0
  v_cvt_pk_bf16_f32 v150, v86, v87
  s_nop 1
  v_cvt_pk_bf16_f32 v151, v88, v89
  v_lshlrev_b32 v86, 16, v150
  v_and_b32 v87, 0xffff0000, v150
  v_lshlrev_b32 v88, 16, v151
  v_and_b32 v89, 0xffff0000, v151
  v_mul_f32 v118, v86, v86
  v_mul_f32 v119, v87, v87
  v_mul_f32 v120, v88, v88
  v_mul_f32 v121, v89, v89
  v_fmamk_f32 v118, v118, 0xbdd2d3e8, v182
  v_fmamk_f32 v119, v119, 0xbdd2d3e8, v182
  v_fmamk_f32 v120, v120, 0xbdd2d3e8, v182
  v_fmamk_f32 v121, v121, 0xbdd2d3e8, v182
  v_mul_f32 v118, v86, v118
  v_mul_f32 v119, v87, v119
  v_mul_f32 v120, v88, v120
  v_mul_f32 v121, v89, v121
  v_exp_f32 v118, v118
  v_exp_f32 v119, v119
  v_exp_f32 v120, v120
  v_exp_f32 v121, v121
  v_add_f32 v118, 1.0, v118
  v_add_f32 v119, 1.0, v119
  v_add_f32 v120, 1.0, v120
  v_add_f32 v121, 1.0, v121
  v_rcp_f32 v118, v118
  v_rcp_f32 v119, v119
  v_rcp_f32 v120, v120
  v_rcp_f32 v121, v121
  v_mul_f32 v118, v86, v118
  v_mul_f32 v119, v87, v119
  v_mul_f32 v120, v88, v120
  v_mul_f32 v121, v89, v121
  v_cvt_pk_bf16_f32 v150, v118, v119
  v_cvt_pk_bf16_f32 v151, v120, v121
  v_dot2_f32_bf16 v166, v150, v72, v166
  v_dot2_f32_bf16 v166, v151, v73, v166
  s_nop 2
  v_mul_f32 v86, v174, v20
  v_mul_f32 v87, v174, v21
  v_mul_f32 v88, v174, v22
  v_mul_f32 v89, v174, v23
  v_cvt_pk_bf16_f32 v150, v86, v87
  v_cvt_pk_bf16_f32 v151, v88, v89
  v_dot2_f32_bf16 v86, v150, s69, v48
  v_dot2_f32_bf16 v87, v150, s70, v49
  v_dot2_f32_bf16 v88, v151, s69, v50
  v_dot2_f32_bf16 v89, v151, s70, v51
  s_nop 0
  v_cvt_pk_bf16_f32 v150, v86, v87
  s_nop 1
  v_cvt_pk_bf16_f32 v151, v88, v89
  v_lshlrev_b32 v86, 16, v150
  v_and_b32 v87, 0xffff0000, v150
  v_lshlrev_b32 v88, 16, v151
  v_and_b32 v89, 0xffff0000, v151
  v_mul_f32 v118, v86, v86
  v_mul_f32 v119, v87, v87
  v_mul_f32 v120, v88, v88
  v_mul_f32 v121, v89, v89
  v_fmamk_f32 v118, v118, 0xbdd2d3e8, v182
  v_fmamk_f32 v119, v119, 0xbdd2d3e8, v182
  v_fmamk_f32 v120, v120, 0xbdd2d3e8, v182
  v_fmamk_f32 v121, v121, 0xbdd2d3e8, v182
  v_mul_f32 v118, v86, v118
  v_mul_f32 v119, v87, v119
  v_mul_f32 v120, v88, v120
  v_mul_f32 v121, v89, v121
  v_exp_f32 v118, v118
  v_exp_f32 v119, v119
  v_exp_f32 v120, v120
  v_exp_f32 v121, v121
  v_add_f32 v118, 1.0, v118
  v_add_f32 v119, 1.0, v119
  v_add_f32 v120, 1.0, v120
  v_add_f32 v121, 1.0, v121
  v_rcp_f32 v118, v118
  v_rcp_f32 v119, v119
  v_rcp_f32 v120, v120
  v_rcp_f32 v121, v121
  v_mul_f32 v118, v86, v118
  v_mul_f32 v119, v87, v119
  v_mul_f32 v120, v88, v120
  v_mul_f32 v121, v89, v121
  v_cvt_pk_bf16_f32 v150, v118, v119
  v_cvt_pk_bf16_f32 v151, v120, v121
  v_dot2_f32_bf16 v166, v150, v74, v166
  v_dot2_f32_bf16 v166, v151, v75, v166
  s_nop 2
  v_mul_f32 v86, v174, v24
  v_mul_f32 v87, v174, v25
  v_mul_f32 v88, v174, v26
  v_mul_f32 v89, v174, v27
  v_cvt_pk_bf16_f32 v150, v86, v87
  v_cvt_pk_bf16_f32 v151, v88, v89
  v_dot2_f32_bf16 v86, v150, s69, v52
  v_dot2_f32_bf16 v87, v150, s70, v53
  v_dot2_f32_bf16 v88, v151, s69, v54
  v_dot2_f32_bf16 v89, v151, s70, v55
  s_nop 0
  v_cvt_pk_bf16_f32 v150, v86, v87
  s_nop 1
  v_cvt_pk_bf16_f32 v151, v88, v89
  v_lshlrev_b32 v86, 16, v150
  v_and_b32 v87, 0xffff0000, v150
  v_lshlrev_b32 v88, 16, v151
  v_and_b32 v89, 0xffff0000, v151
  v_mul_f32 v118, v86, v86
  v_mul_f32 v119, v87, v87
  v_mul_f32 v120, v88, v88
  v_mul_f32 v121, v89, v89
  v_fmamk_f32 v118, v118, 0xbdd2d3e8, v182
  v_fmamk_f32 v119, v119, 0xbdd2d3e8, v182
  v_fmamk_f32 v120, v120, 0xbdd2d3e8, v182
  v_fmamk_f32 v121, v121, 0xbdd2d3e8, v182
  v_mul_f32 v118, v86, v118
  v_mul_f32 v119, v87, v119
  v_mul_f32 v120, v88, v120
  v_mul_f32 v121, v89, v121
  v_exp_f32 v118, v118
  v_exp_f32 v119, v119
  v_exp_f32 v120, v120
  v_exp_f32 v121, v121
  v_add_f32 v118, 1.0, v118
  v_add_f32 v119, 1.0, v119
  v_add_f32 v120, 1.0, v120
  v_add_f32 v121, 1.0, v121
  v_rcp_f32 v118, v118
  v_rcp_f32 v119, v119
  v_rcp_f32 v120, v120
  v_rcp_f32 v121, v121
  v_mul_f32 v118, v86, v118
  v_mul_f32 v119, v87, v119
  v_mul_f32 v120, v88, v120
  v_mul_f32 v121, v89, v121
  v_cvt_pk_bf16_f32 v150, v118, v119
  v_cvt_pk_bf16_f32 v151, v120, v121
  v_dot2_f32_bf16 v166, v150, v76, v166
  v_dot2_f32_bf16 v166, v151, v77, v166
  s_nop 2
  v_mul_f32 v86, v174, v28
  v_mul_f32 v87, v174, v29
  v_mul_f32 v88, v174, v30
  v_mul_f32 v89, v174, v31
  v_cvt_pk_bf16_f32 v150, v86, v87
  v_cvt_pk_bf16_f32 v151, v88, v89
  v_dot2_f32_bf16 v86, v150, s69, v56
  v_dot2_f32_bf16 v87, v150, s70, v57
  v_dot2_f32_bf16 v88, v151, s69, v58
  v_dot2_f32_bf16 v89, v151, s70, v59
  s_nop 0
  v_cvt_pk_bf16_f32 v150, v86, v87
  s_nop 1
  v_cvt_pk_bf16_f32 v151, v88, v89
  v_lshlrev_b32 v86, 16, v150
  v_and_b32 v87, 0xffff0000, v150
  v_lshlrev_b32 v88, 16, v151
  v_and_b32 v89, 0xffff0000, v151
  v_mul_f32 v118, v86, v86
  v_mul_f32 v119, v87, v87
  v_mul_f32 v120, v88, v88
  v_mul_f32 v121, v89, v89
  v_fmamk_f32 v118, v118, 0xbdd2d3e8, v182
  v_fmamk_f32 v119, v119, 0xbdd2d3e8, v182
  v_fmamk_f32 v120, v120, 0xbdd2d3e8, v182
  v_fmamk_f32 v121, v121, 0xbdd2d3e8, v182
  v_mul_f32 v118, v86, v118
  v_mul_f32 v119, v87, v119
  v_mul_f32 v120, v88, v120
  v_mul_f32 v121, v89, v121
  v_exp_f32 v118, v118
  v_exp_f32 v119, v119
  v_exp_f32 v120, v120
  v_exp_f32 v121, v121
  v_add_f32 v118, 1.0, v118
  v_add_f32 v119, 1.0, v119
  v_add_f32 v120, 1.0, v120
  v_add_f32 v121, 1.0, v121
  v_rcp_f32 v118, v118
  v_rcp_f32 v119, v119
  v_rcp_f32 v120, v120
  v_rcp_f32 v121, v121
  v_mul_f32 v118, v86, v118
  v_mul_f32 v119, v87, v119
  v_mul_f32 v120, v88, v120
  v_mul_f32 v121, v89, v121
  v_cvt_pk_bf16_f32 v150, v118, v119
  v_cvt_pk_bf16_f32 v151, v120, v121
  v_dot2_f32_bf16 v166, v150, v78, v166
  v_dot2_f32_bf16 v166, v151, v79, v166
  s_nop 2
  v_mul_f32 v86, v174, v32
  v_mul_f32 v87, v174, v33
  v_mul_f32 v88, v174, v34
  v_mul_f32 v89, v174, v35
  v_cvt_pk_bf16_f32 v150, v86, v87
  v_cvt_pk_bf16_f32 v151, v88, v89
  v_dot2_f32_bf16 v86, v150, s69, v60
  v_dot2_f32_bf16 v87, v150, s70, v61
  v_dot2_f32_bf16 v88, v151, s69, v62
  v_dot2_f32_bf16 v89, v151, s70, v63
  s_nop 0
  v_cvt_pk_bf16_f32 v150, v86, v87
  s_nop 1
  v_cvt_pk_bf16_f32 v151, v88, v89
  v_lshlrev_b32 v86, 16, v150
  v_and_b32 v87, 0xffff0000, v150
  v_lshlrev_b32 v88, 16, v151
  v_and_b32 v89, 0xffff0000, v151
  v_mul_f32 v118, v86, v86
  v_mul_f32 v119, v87, v87
  v_mul_f32 v120, v88, v88
  v_mul_f32 v121, v89, v89
  v_fmamk_f32 v118, v118, 0xbdd2d3e8, v182
  v_fmamk_f32 v119, v119, 0xbdd2d3e8, v182
  v_fmamk_f32 v120, v120, 0xbdd2d3e8, v182
  v_fmamk_f32 v121, v121, 0xbdd2d3e8, v182
  v_mul_f32 v118, v86, v118
  v_mul_f32 v119, v87, v119
  v_mul_f32 v120, v88, v120
  v_mul_f32 v121, v89, v121
  v_exp_f32 v118, v118
  v_exp_f32 v119, v119
  v_exp_f32 v120, v120
  v_exp_f32 v121, v121
  v_add_f32 v118, 1.0, v118
  v_add_f32 v119, 1.0, v119
  v_add_f32 v120, 1.0, v120
  v_add_f32 v121, 1.0, v121
  v_rcp_f32 v118, v118
  v_rcp_f32 v119, v119
  v_rcp_f32 v120, v120
  v_rcp_f32 v121, v121
  v_mul_f32 v118, v86, v118
  v_mul_f32 v119, v87, v119
  v_mul_f32 v120, v88, v120
  v_mul_f32 v121, v89, v121
  v_cvt_pk_bf16_f32 v150, v118, v119
  v_cvt_pk_bf16_f32 v151, v120, v121
  v_dot2_f32_bf16 v166, v150, v80, v166
  v_dot2_f32_bf16 v166, v151, v81, v166
  s_nop 2
  v_mul_f32 v86, v174, v36
  v_mul_f32 v87, v174, v37
  v_mul_f32 v88, v174, v38
  v_mul_f32 v89, v174, v39
  v_cvt_pk_bf16_f32 v150, v86, v87
  v_cvt_pk_bf16_f32 v151, v88, v89
  v_dot2_f32_bf16 v86, v150, s69, v64
  v_dot2_f32_bf16 v87, v150, s70, v65
  v_dot2_f32_bf16 v88, v151, s69, v66
  v_dot2_f32_bf16 v89, v151, s70, v67
  s_nop 0
  v_cvt_pk_bf16_f32 v150, v86, v87
  s_nop 1
  v_cvt_pk_bf16_f32 v151, v88, v89
  v_lshlrev_b32 v86, 16, v150
  v_and_b32 v87, 0xffff0000, v150
  v_lshlrev_b32 v88, 16, v151
  v_and_b32 v89, 0xffff0000, v151
  v_mul_f32 v118, v86, v86
  v_mul_f32 v119, v87, v87
  v_mul_f32 v120, v88, v88
  v_mul_f32 v121, v89, v89
  v_fmamk_f32 v118, v118, 0xbdd2d3e8, v182
  v_fmamk_f32 v119, v119, 0xbdd2d3e8, v182
  v_fmamk_f32 v120, v120, 0xbdd2d3e8, v182
  v_fmamk_f32 v121, v121, 0xbdd2d3e8, v182
  v_mul_f32 v118, v86, v118
  v_mul_f32 v119, v87, v119
  v_mul_f32 v120, v88, v120
  v_mul_f32 v121, v89, v121
  v_exp_f32 v118, v118
  v_exp_f32 v119, v119
  v_exp_f32 v120, v120
  v_exp_f32 v121, v121
  v_add_f32 v118, 1.0, v118
  v_add_f32 v119, 1.0, v119
  v_add_f32 v120, 1.0, v120
  v_add_f32 v121, 1.0, v121
  v_rcp_f32 v118, v118
  v_rcp_f32 v119, v119
  v_rcp_f32 v120, v120
  v_rcp_f32 v121, v121
  v_mul_f32 v118, v86, v118
  v_mul_f32 v119, v87, v119
  v_mul_f32 v120, v88, v120
  v_mul_f32 v121, v89, v121
  v_cvt_pk_bf16_f32 v150, v118, v119
  v_cvt_pk_bf16_f32 v151, v120, v121
  v_dot2_f32_bf16 v166, v150, v82, v166
  v_dot2_f32_bf16 v166, v151, v83, v166
  s_nop 2
  v_mul_f32 v86, v174, v40
  v_mul_f32 v87, v174, v41
  v_mul_f32 v88, v174, v42
  v_mul_f32 v89, v174, v43
  v_cvt_pk_bf16_f32 v150, v86, v87
  v_cvt_pk_bf16_f32 v151, v88, v89
  v_dot2_f32_bf16 v86, v150, s69, v68
  v_dot2_f32_bf16 v87, v150, s70, v69
  v_dot2_f32_bf16 v88, v151, s69, v70
  v_dot2_f32_bf16 v89, v151, s70, v71
  s_nop 0
  v_cvt_pk_bf16_f32 v150, v86, v87
  s_nop 1
  v_cvt_pk_bf16_f32 v151, v88, v89
  v_lshlrev_b32 v86, 16, v150
  v_and_b32 v87, 0xffff0000, v150
  v_lshlrev_b32 v88, 16, v151
  v_and_b32 v89, 0xffff0000, v151
  v_mul_f32 v118, v86, v86
  v_mul_f32 v119, v87, v87
  v_mul_f32 v120, v88, v88
  v_mul_f32 v121, v89, v89
  v_fmamk_f32 v118, v118, 0xbdd2d3e8, v182
  v_fmamk_f32 v119, v119, 0xbdd2d3e8, v182
  v_fmamk_f32 v120, v120, 0xbdd2d3e8, v182
  v_fmamk_f32 v121, v121, 0xbdd2d3e8, v182
  v_mul_f32 v118, v86, v118
  v_mul_f32 v119, v87, v119
  v_mul_f32 v120, v88, v120
  v_mul_f32 v121, v89, v121
  v_exp_f32 v118, v118
  v_exp_f32 v119, v119
  v_exp_f32 v120, v120
  v_exp_f32 v121, v121
  v_add_f32 v118, 1.0, v118
  v_add_f32 v119, 1.0, v119
  v_add_f32 v120, 1.0, v120
  v_add_f32 v121, 1.0, v121
  v_rcp_f32 v118, v118
  v_rcp_f32 v119, v119
  v_rcp_f32 v120, v120
  v_rcp_f32 v121, v121
  v_mul_f32 v118, v86, v118
  v_mul_f32 v119, v87, v119
  v_mul_f32 v120, v88, v120
  v_mul_f32 v121, v89, v121
  v_cvt_pk_bf16_f32 v150, v118, v119
  v_cvt_pk_bf16_f32 v151, v120, v121
  v_dot2_f32_bf16 v166, v150, v84, v166
  v_dot2_f32_bf16 v166, v151, v85, v166
  s_nop 2
  s_nop 1
  v_add_f32_dpp v166, v166, v166 quad_perm:[1,0,3,2] row_mask:0xf bank_mask:0xf
  s_nop 1
  v_add_f32_dpp v166, v166, v166 quad_perm:[2,3,0,1] row_mask:0xf bank_mask:0xf
  s_nop 1
  v_add_f32_dpp v166, v166, v166 row_half_mirror row_mask:0xf bank_mask:0xf
  s_nop 1
  v_add_f32_dpp v166, v166, v166 row_mirror row_mask:0xf bank_mask:0xf
  v_mov_b32 v150, v166
  s_nop 1
  v_permlane16_swap_b32 v166, v150
  s_nop 0
  v_add_f32 v166, v166, v150
  v_mov_b32 v150, v166
  s_nop 1
  v_permlane32_swap_b32 v166, v150
  s_nop 0
  v_add_f32 v166, v166, v150
  v_cvt_pk_bf16_f32 v166, v166, v166
  v_lshlrev_b32 v166, 16, v166
  v_add_f32 v166, s59, v166
  v_cvt_pk_bf16_f32 v166, v166, v166
  v_lshlrev_b32 v166, 16, v166
  s_lshl_b64 exec, 1, s96
  v_mov_b32 v189, v166
  s_mov_b64 exec, -1
  s_branch Lfb_17
Lfbd_18:
L_nofb:
  v_pk_add_f32 v[188:189], v[188:189], v[184:185]
  v_cvt_pk_bf16_f32 v188, v188, v189
  buffer_store_dword v188, v8, s[36:39], s92 offen
  s_branch L_fin
L_stream:
  s_setprio 2
  s_sub_u32 s62, s3, 4
  s_lshl_b32 s56, s54, 23
  s_lshl_b32 s93, s52, 20
  s_add_u32 s56, s56, s93
  s_lshl_b32 s93, s62, 12
  s_add_u32 s56, s56, s93
  s_lshl_b32 s93, s55, 14
  s_add_u32 s56, s56, s93
  s_lshl_b32 s57, s62, 15
  v_xor_b32 v238, v12, v13
  v_lshlrev_b32 v239, 8, v13
  v_lshlrev_b32 v240, 8, v12
  v_add_u32 v240, s57, v240
  v_xor_b32 v241, 0, v238
  v_lshlrev_b32 v241, 4, v241
  v_add_u32 v2, v239, v241
  v_add_u32 v6, v240, v241
  v_xor_b32 v241, 4, v238
  v_lshlrev_b32 v241, 4, v241
  v_add_u32 v3, v239, v241
  v_add_u32 v7, v240, v241
  v_xor_b32 v241, 8, v238
  v_lshlrev_b32 v241, 4, v241
  v_add_u32 v4, v239, v241
  v_add_u32 v8, v240, v241
  v_xor_b32 v241, 12, v238
  v_lshlrev_b32 v241, 4, v241
  v_add_u32 v5, v239, v241
  v_add_u32 v9, v240, v241
  v_lshlrev_b32 v10, 10, v13
  v_lshl_add_u32 v10, v12, 4, v10
  s_waitcnt lgkmcnt(0)
  s_mov_b32 s8, s66
  s_and_b32 s9, s67, 0xffff
  s_mov_b32 s10, 67108864
  s_mov_b32 s11, 0x20000
  s_mov_b32 s12, s68
  s_and_b32 s13, s69, 0xffff
  s_mov_b32 s14, 67108864
  s_mov_b32 s15, 0x20000
  s_barrier
  s_add_u32 s94, s57, 0
  s_mov_b32 m0, s94
  s_add_u32 s95, s56, 0
  buffer_load_dwordx4 v2, s[8:11], s95 offen offset:0 nt lds
  buffer_load_dwordx4 v3, s[8:11], s95 offen offset:1024 nt lds
  buffer_load_dwordx4 v4, s[8:11], s95 offen offset:2048 nt lds
  buffer_load_dwordx4 v5, s[8:11], s95 offen offset:3072 nt lds
  s_add_u32 s94, s57, 4096
  s_mov_b32 m0, s94
  s_add_u32 s95, s56, 65536
  buffer_load_dwordx4 v2, s[8:11], s95 offen offset:0 nt lds
  buffer_load_dwordx4 v3, s[8:11], s95 offen offset:1024 nt lds
  buffer_load_dwordx4 v4, s[8:11], s95 offen offset:2048 nt lds
  buffer_load_dwordx4 v5, s[8:11], s95 offen offset:3072 nt lds
  s_add_u32 s94, s57, 8192
  s_mov_b32 m0, s94
  s_add_u32 s95, s56, 131072
  buffer_load_dwordx4 v2, s[8:11], s95 offen offset:0 nt lds
  buffer_load_dwordx4 v3, s[8:11], s95 offen offset:1024 nt lds
  buffer_load_dwordx4 v4, s[8:11], s95 offen offset:2048 nt lds
  buffer_load_dwordx4 v5, s[8:11], s95 offen offset:3072 nt lds
  v_lshrrev_b32 v238, 2, v12
  v_and_b32 v239, 1, v238
  v_lshlrev_b32 v239, 4, v239
  v_mov_b32 v240, 0xffff
  v_lshlrev_b32 v240, v239, v240
  v_cmp_gt_u32 vcc, 2, v238
  s_nop 1
  v_cndmask_b32 v11, 0, v240, vcc
  v_cndmask_b32 v14, v240, 0, vcc
  v_mov_b32 v24, 0
  v_mov_b32 v25, 0
  v_mov_b32 v28, 0
  v_mov_b32 v29, 0
  v_mov_b32 v30, 0
  v_mov_b32 v31, 0
  v_mov_b32 v34, 0
  v_mov_b32 v35, 0
  v_mov_b32 v16, 0
  v_mov_b32 v17, 0
  v_mov_b32 v18, 0
  v_mov_b32 v19, 0
  v_mov_b32 v20, 0
  v_mov_b32 v21, 0
  v_mov_b32 v22, 0
  v_mov_b32 v23, 0
  s_mov_b32 s68, 0x3fb8aa3b
  s_waitcnt vmcnt(8)
  s_add_u32 s94, s57, 12288
  s_mov_b32 m0, s94
  s_add_u32 s95, s56, 196608
  buffer_load_dwordx4 v2, s[8:11], s95 offen offset:0 nt lds
  buffer_load_dwordx4 v3, s[8:11], s95 offen offset:1024 nt lds
  buffer_load_dwordx4 v4, s[8:11], s95 offen offset:2048 nt lds
  buffer_load_dwordx4 v5, s[8:11], s95 offen offset:3072 nt lds
  s_waitcnt vmcnt(8)
  s_add_u32 s94, s57, 16384
  s_mov_b32 m0, s94
  s_add_u32 s95, s56, 262144
  buffer_load_dwordx4 v2, s[8:11], s95 offen offset:0 nt lds
  buffer_load_dwordx4 v3, s[8:11], s95 offen offset:1024 nt lds
  buffer_load_dwordx4 v4, s[8:11], s95 offen offset:2048 nt lds
  buffer_load_dwordx4 v5, s[8:11], s95 offen offset:3072 nt lds
  s_waitcnt vmcnt(8)
  s_add_u32 s94, s57, 20480
  s_mov_b32 m0, s94
  s_add_u32 s95, s56, 327680
  buffer_load_dwordx4 v2, s[8:11], s95 offen offset:0 nt lds
  buffer_load_dwordx4 v3, s[8:11], s95 offen offset:1024 nt lds
  buffer_load_dwordx4 v4, s[8:11], s95 offen offset:2048 nt lds
  buffer_load_dwordx4 v5, s[8:11], s95 offen offset:3072 nt lds
  s_waitcnt vmcnt(8)
  s_add_u32 s94, s57, 24576
  s_mov_b32 m0, s94
  s_add_u32 s95, s56, 393216
  buffer_load_dwordx4 v2, s[8:11], s95 offen offset:0 nt lds
  buffer_load_dwordx4 v3, s[8:11], s95 offen offset:1024 nt lds
  buffer_load_dwordx4 v4, s[8:11], s95 offen offset:2048 nt lds
  buffer_load_dwordx4 v5, s[8:11], s95 offen offset:3072 nt lds
  s_waitcnt vmcnt(8)
  s_add_u32 s94, s57, 28672
  s_mov_b32 m0, s94
  s_add_u32 s95, s56, 458752
  buffer_load_dwordx4 v2, s[8:11], s95 offen offset:0 nt lds
  buffer_load_dwordx4 v3, s[8:11], s95 offen offset:1024 nt lds
  buffer_load_dwordx4 v4, s[8:11], s95 offen offset:2048 nt lds
  buffer_load_dwordx4 v5, s[8:11], s95 offen offset:3072 nt lds
  s_waitcnt vmcnt(8)
  s_add_u32 s95, s56, 0
  buffer_load_dwordx4 v[124:127], v10, s[12:15], s95 offen offset:0 nt
  buffer_load_dwordx4 v[128:131], v10, s[12:15], s95 offen offset:256 nt
  buffer_load_dwordx4 v[132:135], v10, s[12:15], s95 offen offset:512 nt
  buffer_load_dwordx4 v[136:139], v10, s[12:15], s95 offen offset:768 nt
  s_waitcnt vmcnt(8)
  s_add_u32 s95, s56, 65536
  buffer_load_dwordx4 v[140:143], v10, s[12:15], s95 offen offset:0 nt
  buffer_load_dwordx4 v[144:147], v10, s[12:15], s95 offen offset:256 nt
  buffer_load_dwordx4 v[148:151], v10, s[12:15], s95 offen offset:512 nt
  buffer_load_dwordx4 v[152:155], v10, s[12:15], s95 offen offset:768 nt
  s_waitcnt vmcnt(8)
  s_add_u32 s95, s56, 131072
  buffer_load_dwordx4 v[156:159], v10, s[12:15], s95 offen offset:0 nt
  buffer_load_dwordx4 v[160:163], v10, s[12:15], s95 offen offset:256 nt
  buffer_load_dwordx4 v[164:167], v10, s[12:15], s95 offen offset:512 nt
  buffer_load_dwordx4 v[168:171], v10, s[12:15], s95 offen offset:768 nt
  s_waitcnt vmcnt(8)
  s_add_u32 s95, s56, 196608
  buffer_load_dwordx4 v[172:175], v10, s[12:15], s95 offen offset:0 nt
  buffer_load_dwordx4 v[176:179], v10, s[12:15], s95 offen offset:256 nt
  buffer_load_dwordx4 v[180:183], v10, s[12:15], s95 offen offset:512 nt
  buffer_load_dwordx4 v[184:187], v10, s[12:15], s95 offen offset:768 nt
  s_waitcnt vmcnt(8)
  s_add_u32 s95, s56, 262144
  buffer_load_dwordx4 v[188:191], v10, s[12:15], s95 offen offset:0 nt
  buffer_load_dwordx4 v[192:195], v10, s[12:15], s95 offen offset:256 nt
  buffer_load_dwordx4 v[196:199], v10, s[12:15], s95 offen offset:512 nt
  buffer_load_dwordx4 v[200:203], v10, s[12:15], s95 offen offset:768 nt
  v_and_b32 v240, 3, v12
  v_lshlrev_b32 v240, 8, v240
  v_lshl_add_u32 v240, v13, 4, v240
  v_add_u32 v240, 157696, v240
  v_mov_b32 v238, 158920
  s_mov_b32 s63, 800000
Lw_19:
  ds_read_b32 v239, v238
  s_waitcnt lgkmcnt(0)
  v_readfirstlane_b32 s99, v239
  s_nop 0
  s_cmp_ge_u32 s99, 1
  s_cbranch_scc1 Lwd_20
  s_sleep 1
  s_sub_u32 s63, s63, 1
  s_cbranch_scc0 Lw_19
Lwd_20:
  ds_read_b128 v[36:39], v240 offset:0
  ds_read_b128 v[40:43], v240 offset:64
  ds_read_b128 v[44:47], v240 offset:128
  ds_read_b128 v[48:51], v240 offset:192
  s_waitcnt vmcnt(48)
  ds_read_b128 v[92:95], v6 offset:0
  ds_read_b128 v[96:99], v7 offset:0
  ds_read_b128 v[100:103], v8 offset:0
  ds_read_b128 v[104:107], v9 offset:0
  s_waitcnt vmcnt(44)
  ds_read_b128 v[108:111], v6 offset:4096
  ds_read_b128 v[112:115], v7 offset:4096
  ds_read_b128 v[116:119], v8 offset:4096
  ds_read_b128 v[120:123], v9 offset:4096
  s_waitcnt lgkmcnt(4)
  v_mfma_f32_16x16x32_bf16 v[52:55], v[92:95], v[36:39], 0
  v_mfma_f32_16x16x32_bf16 v[52:55], v[96:99], v[40:43], v[52:55]
  v_mfma_f32_16x16x32_bf16 v[52:55], v[100:103], v[44:47], v[52:55]
  v_mfma_f32_16x16x32_bf16 v[52:55], v[104:107], v[48:51], v[52:55]
  s_waitcnt vmcnt(40)
  ds_read_b128 v[92:95], v6 offset:8192
  ds_read_b128 v[96:99], v7 offset:8192
  ds_read_b128 v[100:103], v8 offset:8192
  ds_read_b128 v[104:107], v9 offset:8192
  s_waitcnt lgkmcnt(4)
  v_mfma_f32_16x16x32_bf16 v[56:59], v[108:111], v[36:39], 0
  v_mfma_f32_16x16x32_bf16 v[56:59], v[112:115], v[40:43], v[56:59]
  v_mfma_f32_16x16x32_bf16 v[56:59], v[116:119], v[44:47], v[56:59]
  v_mfma_f32_16x16x32_bf16 v[56:59], v[120:123], v[48:51], v[56:59]
  s_waitcnt vmcnt(36)
  ds_read_b128 v[108:111], v6 offset:12288
  ds_read_b128 v[112:115], v7 offset:12288
  ds_read_b128 v[116:119], v8 offset:12288
  ds_read_b128 v[120:123], v9 offset:12288
  s_waitcnt lgkmcnt(4)
  v_mfma_f32_16x16x32_bf16 v[60:63], v[92:95], v[36:39], 0
  v_mfma_f32_16x16x32_bf16 v[60:63], v[96:99], v[40:43], v[60:63]
  v_mfma_f32_16x16x32_bf16 v[60:63], v[100:103], v[44:47], v[60:63]
  v_mfma_f32_16x16x32_bf16 v[60:63], v[104:107], v[48:51], v[60:63]
  s_waitcnt lgkmcnt(0)
  v_mfma_f32_16x16x32_bf16 v[64:67], v[108:111], v[36:39], 0
  v_mfma_f32_16x16x32_bf16 v[64:67], v[112:115], v[40:43], v[64:67]
  v_mfma_f32_16x16x32_bf16 v[64:67], v[116:119], v[44:47], v[64:67]
  v_mfma_f32_16x16x32_bf16 v[64:67], v[120:123], v[48:51], v[64:67]
  s_waitcnt vmcnt(8)
  s_add_u32 s95, s56, 327680
  buffer_load_dwordx4 v[204:207], v10, s[12:15], s95 offen offset:0 nt
  buffer_load_dwordx4 v[208:211], v10, s[12:15], s95 offen offset:256 nt
  buffer_load_dwordx4 v[212:215], v10, s[12:15], s95 offen offset:512 nt
  buffer_load_dwordx4 v[216:219], v10, s[12:15], s95 offen offset:768 nt
  s_waitcnt vmcnt(36)
  ds_read_b128 v[92:95], v6 offset:16384
  ds_read_b128 v[96:99], v7 offset:16384
  ds_read_b128 v[100:103], v8 offset:16384
  ds_read_b128 v[104:107], v9 offset:16384
  s_waitcnt vmcnt(32)
  ds_read_b128 v[108:111], v6 offset:20480
  ds_read_b128 v[112:115], v7 offset:20480
  ds_read_b128 v[116:119], v8 offset:20480
  ds_read_b128 v[120:123], v9 offset:20480
  s_waitcnt lgkmcnt(4)
  v_mfma_f32_16x16x32_bf16 v[68:71], v[92:95], v[36:39], 0
  v_mfma_f32_16x16x32_bf16 v[68:71], v[96:99], v[40:43], v[68:71]
  v_mfma_f32_16x16x32_bf16 v[68:71], v[100:103], v[44:47], v[68:71]
  v_mfma_f32_16x16x32_bf16 v[68:71], v[104:107], v[48:51], v[68:71]
  s_waitcnt vmcnt(28)
  ds_read_b128 v[92:95], v6 offset:24576
  ds_read_b128 v[96:99], v7 offset:24576
  ds_read_b128 v[100:103], v8 offset:24576
  ds_read_b128 v[104:107], v9 offset:24576
  s_waitcnt lgkmcnt(4)
  v_mfma_f32_16x16x32_bf16 v[72:75], v[108:111], v[36:39], 0
  v_mfma_f32_16x16x32_bf16 v[72:75], v[112:115], v[40:43], v[72:75]
  v_mfma_f32_16x16x32_bf16 v[72:75], v[116:119], v[44:47], v[72:75]
  v_mfma_f32_16x16x32_bf16 v[72:75], v[120:123], v[48:51], v[72:75]
  s_waitcnt vmcnt(24)
  ds_read_b128 v[108:111], v6 offset:28672
  ds_read_b128 v[112:115], v7 offset:28672
  ds_read_b128 v[116:119], v8 offset:28672
  ds_read_b128 v[120:123], v9 offset:28672
  s_waitcnt lgkmcnt(4)
  v_mfma_f32_16x16x32_bf16 v[76:79], v[92:95], v[36:39], 0
  v_mfma_f32_16x16x32_bf16 v[76:79], v[96:99], v[40:43], v[76:79]
  v_mfma_f32_16x16x32_bf16 v[76:79], v[100:103], v[44:47], v[76:79]
  v_mfma_f32_16x16x32_bf16 v[76:79], v[104:107], v[48:51], v[76:79]
  s_waitcnt lgkmcnt(0)
  v_mfma_f32_16x16x32_bf16 v[80:83], v[108:111], v[36:39], 0
  v_mfma_f32_16x16x32_bf16 v[80:83], v[112:115], v[40:43], v[80:83]
  v_mfma_f32_16x16x32_bf16 v[80:83], v[116:119], v[44:47], v[80:83]
  v_mfma_f32_16x16x32_bf16 v[80:83], v[120:123], v[48:51], v[80:83]
  s_nop 3
  v_cvt_pk_bf16_f32 v238, v52, v53
  v_cvt_pk_bf16_f32 v239, v54, v55
  v_cvt_pk_bf16_f32 v240, v56, v57
  v_cvt_pk_bf16_f32 v241, v58, v59
  v_cvt_pk_bf16_f32 v242, v60, v61
  v_cvt_pk_bf16_f32 v243, v62, v63
  v_cvt_pk_bf16_f32 v244, v64, v65
  v_cvt_pk_bf16_f32 v245, v66, v67
  v_lshlrev_b32 v52, 16, v238
  v_and_b32 v53, 0xffff0000, v238
  v_lshlrev_b32 v54, 16, v239
  v_and_b32 v55, 0xffff0000, v239
  v_lshlrev_b32 v56, 16, v240
  v_and_b32 v57, 0xffff0000, v240
  v_lshlrev_b32 v58, 16, v241
  v_and_b32 v59, 0xffff0000, v241
  v_lshlrev_b32 v60, 16, v242
  v_and_b32 v61, 0xffff0000, v242
  v_lshlrev_b32 v62, 16, v243
  v_and_b32 v63, 0xffff0000, v243
  v_lshlrev_b32 v64, 16, v244
  v_and_b32 v65, 0xffff0000, v244
  v_lshlrev_b32 v66, 16, v245
  v_and_b32 v67, 0xffff0000, v245
  v_mul_f32 v52, 0x3db504f3, v52
  v_mul_f32 v53, 0x3db504f3, v53
  v_mul_f32 v54, 0x3db504f3, v54
  v_mul_f32 v55, 0x3db504f3, v55
  v_mul_f32 v56, 0x3db504f3, v56
  v_mul_f32 v57, 0x3db504f3, v57
  v_mul_f32 v58, 0x3db504f3, v58
  v_mul_f32 v59, 0x3db504f3, v59
  v_mul_f32 v60, 0x3db504f3, v60
  v_mul_f32 v61, 0x3db504f3, v61
  v_mul_f32 v62, 0x3db504f3, v62
  v_mul_f32 v63, 0x3db504f3, v63
  v_mul_f32 v64, 0x3db504f3, v64
  v_mul_f32 v65, 0x3db504f3, v65
  v_mul_f32 v66, 0x3db504f3, v66
  v_mul_f32 v67, 0x3db504f3, v67
  v_cvt_pk_bf16_f32 v238, v52, v53
  v_cvt_pk_bf16_f32 v239, v54, v55
  v_cvt_pk_bf16_f32 v240, v56, v57
  v_cvt_pk_bf16_f32 v241, v58, v59
  v_cvt_pk_bf16_f32 v242, v60, v61
  v_cvt_pk_bf16_f32 v243, v62, v63
  v_cvt_pk_bf16_f32 v244, v64, v65
  v_cvt_pk_bf16_f32 v245, v66, v67
  v_lshlrev_b32 v52, 16, v238
  v_and_b32 v53, 0xffff0000, v238
  v_lshlrev_b32 v54, 16, v239
  v_and_b32 v55, 0xffff0000, v239
  v_lshlrev_b32 v56, 16, v240
  v_and_b32 v57, 0xffff0000, v240
  v_lshlrev_b32 v58, 16, v241
  v_and_b32 v59, 0xffff0000, v241
  v_lshlrev_b32 v60, 16, v242
  v_and_b32 v61, 0xffff0000, v242
  v_lshlrev_b32 v62, 16, v243
  v_and_b32 v63, 0xffff0000, v243
  v_lshlrev_b32 v64, 16, v244
  v_and_b32 v65, 0xffff0000, v244
  v_lshlrev_b32 v66, 16, v245
  v_and_b32 v67, 0xffff0000, v245
  s_waitcnt vmcnt(8)
  s_add_u32 s95, s56, 393216
  buffer_load_dwordx4 v[220:223], v10, s[12:15], s95 offen offset:0 nt
  buffer_load_dwordx4 v[224:227], v10, s[12:15], s95 offen offset:256 nt
  buffer_load_dwordx4 v[228:231], v10, s[12:15], s95 offen offset:512 nt
  buffer_load_dwordx4 v[232:235], v10, s[12:15], s95 offen offset:768 nt
  s_nop 3
  v_cvt_pk_bf16_f32 v238, v68, v69
  v_cvt_pk_bf16_f32 v239, v70, v71
  v_cvt_pk_bf16_f32 v240, v72, v73
  v_cvt_pk_bf16_f32 v241, v74, v75
  v_cvt_pk_bf16_f32 v242, v76, v77
  v_cvt_pk_bf16_f32 v243, v78, v79
  v_cvt_pk_bf16_f32 v244, v80, v81
  v_cvt_pk_bf16_f32 v245, v82, v83
  v_lshlrev_b32 v68, 16, v238
  v_and_b32 v69, 0xffff0000, v238
  v_lshlrev_b32 v70, 16, v239
  v_and_b32 v71, 0xffff0000, v239
  v_lshlrev_b32 v72, 16, v240
  v_and_b32 v73, 0xffff0000, v240
  v_lshlrev_b32 v74, 16, v241
  v_and_b32 v75, 0xffff0000, v241
  v_lshlrev_b32 v76, 16, v242
  v_and_b32 v77, 0xffff0000, v242
  v_lshlrev_b32 v78, 16, v243
  v_and_b32 v79, 0xffff0000, v243
  v_lshlrev_b32 v80, 16, v244
  v_and_b32 v81, 0xffff0000, v244
  v_lshlrev_b32 v82, 16, v245
  v_and_b32 v83, 0xffff0000, v245
  v_mul_f32 v68, 0x3db504f3, v68
  v_mul_f32 v69, 0x3db504f3, v69
  v_mul_f32 v70, 0x3db504f3, v70
  v_mul_f32 v71, 0x3db504f3, v71
  v_mul_f32 v72, 0x3db504f3, v72
  v_mul_f32 v73, 0x3db504f3, v73
  v_mul_f32 v74, 0x3db504f3, v74
  v_mul_f32 v75, 0x3db504f3, v75
  v_mul_f32 v76, 0x3db504f3, v76
  v_mul_f32 v77, 0x3db504f3, v77
  v_mul_f32 v78, 0x3db504f3, v78
  v_mul_f32 v79, 0x3db504f3, v79
  v_mul_f32 v80, 0x3db504f3, v80
  v_mul_f32 v81, 0x3db504f3, v81
  v_mul_f32 v82, 0x3db504f3, v82
  v_mul_f32 v83, 0x3db504f3, v83
  v_cvt_pk_bf16_f32 v238, v68, v69
  v_cvt_pk_bf16_f32 v239, v70, v71
  v_cvt_pk_bf16_f32 v240, v72, v73
  v_cvt_pk_bf16_f32 v241, v74, v75
  v_cvt_pk_bf16_f32 v242, v76, v77
  v_cvt_pk_bf16_f32 v243, v78, v79
  v_cvt_pk_bf16_f32 v244, v80, v81
  v_cvt_pk_bf16_f32 v245, v82, v83
  v_lshlrev_b32 v68, 16, v238
  v_and_b32 v69, 0xffff0000, v238
  v_lshlrev_b32 v70, 16, v239
  v_and_b32 v71, 0xffff0000, v239
  v_lshlrev_b32 v72, 16, v240
  v_and_b32 v73, 0xffff0000, v240
  v_lshlrev_b32 v74, 16, v241
  v_and_b32 v75, 0xffff0000, v241
  v_lshlrev_b32 v76, 16, v242
  v_and_b32 v77, 0xffff0000, v242
  v_lshlrev_b32 v78, 16, v243
  v_and_b32 v79, 0xffff0000, v243
  v_lshlrev_b32 v80, 16, v244
  v_and_b32 v81, 0xffff0000, v244
  v_lshlrev_b32 v82, 16, v245
  v_and_b32 v83, 0xffff0000, v245
  v_max3_f32 v238, v52, v56, v60
  v_max3_f32 v239, v53, v57, v61
  v_max3_f32 v240, v54, v58, v62
  v_max3_f32 v241, v55, v59, v63
  v_max3_f32 v238, v238, v64, v68
  v_max3_f32 v239, v239, v65, v69
  v_max3_f32 v240, v240, v66, v70
  v_max3_f32 v241, v241, v67, v71
  v_max3_f32 v238, v238, v72, v76
  v_max3_f32 v239, v239, v73, v77
  v_max3_f32 v240, v240, v74, v78
  v_max3_f32 v241, v241, v75, v79
  v_max3_f32 v242, v238, v239, v240
  v_max_f32 v242, v242, v241
  v_mov_b32 v238, v242
  s_nop 1
  v_permlane16_swap_b32 v242, v238
  s_nop 0
  v_max_f32 v242, v242, v238
  v_mov_b32 v238, v242
  s_nop 1
  v_permlane32_swap_b32 v242, v238
  s_nop 0
  v_max_f32 v242, v242, v238
  v_mov_b32 v15, v242
  v_mul_f32 v238, 0xbfb8aa3b, v242
  v_mov_b32 v244, s68
  v_fma_f32 v52, v52, v244, v238
  v_fma_f32 v53, v53, v244, v238
  v_fma_f32 v54, v54, v244, v238
  v_fma_f32 v55, v55, v244, v238
  v_fma_f32 v56, v56, v244, v238
  v_fma_f32 v57, v57, v244, v238
  v_fma_f32 v58, v58, v244, v238
  v_fma_f32 v59, v59, v244, v238
  v_fma_f32 v60, v60, v244, v238
  v_fma_f32 v61, v61, v244, v238
  v_fma_f32 v62, v62, v244, v238
  v_fma_f32 v63, v63, v244, v238
  v_fma_f32 v64, v64, v244, v238
  v_fma_f32 v65, v65, v244, v238
  v_fma_f32 v66, v66, v244, v238
  v_fma_f32 v67, v67, v244, v238
  v_fma_f32 v68, v68, v244, v238
  v_fma_f32 v69, v69, v244, v238
  v_fma_f32 v70, v70, v244, v238
  v_fma_f32 v71, v71, v244, v238
  v_fma_f32 v72, v72, v244, v238
  v_fma_f32 v73, v73, v244, v238
  v_fma_f32 v74, v74, v244, v238
  v_fma_f32 v75, v75, v244, v238
  v_fma_f32 v76, v76, v244, v238
  v_fma_f32 v77, v77, v244, v238
  v_fma_f32 v78, v78, v244, v238
  v_fma_f32 v79, v79, v244, v238
  v_exp_f32 v52, v52
  v_exp_f32 v53, v53
  v_exp_f32 v54, v54
  v_exp_f32 v55, v55
  v_exp_f32 v56, v56
  v_exp_f32 v57, v57
  v_exp_f32 v58, v58
  v_exp_f32 v59, v59
  v_exp_f32 v60, v60
  v_exp_f32 v61, v61
  v_exp_f32 v62, v62
  v_exp_f32 v63, v63
  v_exp_f32 v64, v64
  v_exp_f32 v65, v65
  v_exp_f32 v66, v66
  v_exp_f32 v67, v67
  v_exp_f32 v68, v68
  v_exp_f32 v69, v69
  v_exp_f32 v70, v70
  v_exp_f32 v71, v71
  v_exp_f32 v72, v72
  v_exp_f32 v73, v73
  v_exp_f32 v74, v74
  v_exp_f32 v75, v75
  v_exp_f32 v76, v76
  v_exp_f32 v77, v77
  v_exp_f32 v78, v78
  v_exp_f32 v79, v79
  v_add_f32 v239, v52, v56
  v_add_f32 v240, v53, v57
  v_add_f32 v241, v54, v58
  v_add_f32 v242, v55, v59
  v_add_f32 v239, v239, v60
  v_add_f32 v240, v240, v61
  v_add_f32 v241, v241, v62
  v_add_f32 v242, v242, v63
  v_add_f32 v239, v239, v64
  v_add_f32 v240, v240, v65
  v_add_f32 v241, v241, v66
  v_add_f32 v242, v242, v67
  v_add_f32 v239, v239, v68
  v_add_f32 v240, v240, v69
  v_add_f32 v241, v241, v70
  v_add_f32 v242, v242, v71
  v_add_f32 v239, v239, v72
  v_add_f32 v240, v240, v73
  v_add_f32 v241, v241, v74
  v_add_f32 v242, v242, v75
  v_add_f32 v239, v239, v76
  v_add_f32 v240, v240, v77
  v_add_f32 v241, v241, v78
  v_add_f32 v242, v242, v79
  v_add_f32 v239, v239, v240
  v_add_f32 v241, v241, v242
  v_add_f32 v239, v239, v241
  v_mov_b32 v240, v239
  s_nop 1
  v_permlane16_swap_b32 v239, v240
  s_nop 0
  v_add_f32 v239, v239, v240
  v_mov_b32 v240, v239
  s_nop 1
  v_permlane32_swap_b32 v239, v240
  s_nop 0
  v_add_f32 v239, v239, v240
  v_mov_b32 v236, v239
  v_cvt_pk_bf16_f32 v52, v52, v52
  v_cvt_pk_bf16_f32 v53, v53, v53
  v_cvt_pk_bf16_f32 v54, v54, v54
  v_cvt_pk_bf16_f32 v55, v55, v55
  v_cvt_pk_bf16_f32 v56, v56, v56
  v_cvt_pk_bf16_f32 v57, v57, v57
  v_cvt_pk_bf16_f32 v58, v58, v58
  v_cvt_pk_bf16_f32 v59, v59, v59
  v_cvt_pk_bf16_f32 v60, v60, v60
  v_cvt_pk_bf16_f32 v61, v61, v61
  v_cvt_pk_bf16_f32 v62, v62, v62
  v_cvt_pk_bf16_f32 v63, v63, v63
  v_cvt_pk_bf16_f32 v64, v64, v64
  v_cvt_pk_bf16_f32 v65, v65, v65
  v_cvt_pk_bf16_f32 v66, v66, v66
  v_cvt_pk_bf16_f32 v67, v67, v67
  v_cvt_pk_bf16_f32 v68, v68, v68
  v_cvt_pk_bf16_f32 v69, v69, v69
  v_cvt_pk_bf16_f32 v70, v70, v70
  v_cvt_pk_bf16_f32 v71, v71, v71
  v_cvt_pk_bf16_f32 v72, v72, v72
  v_cvt_pk_bf16_f32 v73, v73, v73
  v_cvt_pk_bf16_f32 v74, v74, v74
  v_cvt_pk_bf16_f32 v75, v75, v75
  v_cvt_pk_bf16_f32 v76, v76, v76
  v_cvt_pk_bf16_f32 v77, v77, v77
  v_cvt_pk_bf16_f32 v78, v78, v78
  v_cvt_pk_bf16_f32 v79, v79, v79
  s_waitcnt vmcnt(8)
  s_add_u32 s94, s57, 0
  s_mov_b32 m0, s94
  s_add_u32 s95, s56, 524288
  buffer_load_dwordx4 v2, s[8:11], s95 offen offset:0 nt lds
  buffer_load_dwordx4 v3, s[8:11], s95 offen offset:1024 nt lds
  buffer_load_dwordx4 v4, s[8:11], s95 offen offset:2048 nt lds
  buffer_load_dwordx4 v5, s[8:11], s95 offen offset:3072 nt lds
  s_waitcnt vmcnt(28)
  v_and_b32 v26, v52, v11
  v_and_b32 v27, v52, v14
  s_nop 1
  v_mfma_f32_16x16x32_bf16 v[16:19], v[26:29], v[124:127], v[16:19]
  v_mfma_f32_16x16x32_bf16 v[20:23], v[24:27], v[124:127], v[20:23]
  v_and_b32 v32, v53, v11
  v_and_b32 v33, v53, v14
  s_nop 1
  v_mfma_f32_16x16x32_bf16 v[16:19], v[32:35], v[128:131], v[16:19]
  v_mfma_f32_16x16x32_bf16 v[20:23], v[30:33], v[128:131], v[20:23]
  v_and_b32 v26, v54, v11
  v_and_b32 v27, v54, v14
  s_nop 1
  v_mfma_f32_16x16x32_bf16 v[16:19], v[26:29], v[132:135], v[16:19]
  v_mfma_f32_16x16x32_bf16 v[20:23], v[24:27], v[132:135], v[20:23]
  v_and_b32 v32, v55, v11
  v_and_b32 v33, v55, v14
  s_nop 1
  v_mfma_f32_16x16x32_bf16 v[16:19], v[32:35], v[136:139], v[16:19]
  v_mfma_f32_16x16x32_bf16 v[20:23], v[30:33], v[136:139], v[20:23]
  s_waitcnt vmcnt(24)
  v_and_b32 v26, v56, v11
  v_and_b32 v27, v56, v14
  s_nop 1
  v_mfma_f32_16x16x32_bf16 v[16:19], v[26:29], v[140:143], v[16:19]
  v_mfma_f32_16x16x32_bf16 v[20:23], v[24:27], v[140:143], v[20:23]
  v_and_b32 v32, v57, v11
  v_and_b32 v33, v57, v14
  s_nop 1
  v_mfma_f32_16x16x32_bf16 v[16:19], v[32:35], v[144:147], v[16:19]
  v_mfma_f32_16x16x32_bf16 v[20:23], v[30:33], v[144:147], v[20:23]
  v_and_b32 v26, v58, v11
  v_and_b32 v27, v58, v14
  s_nop 1
  v_mfma_f32_16x16x32_bf16 v[16:19], v[26:29], v[148:151], v[16:19]
  v_mfma_f32_16x16x32_bf16 v[20:23], v[24:27], v[148:151], v[20:23]
  v_and_b32 v32, v59, v11
  v_and_b32 v33, v59, v14
  s_nop 1
  v_mfma_f32_16x16x32_bf16 v[16:19], v[32:35], v[152:155], v[16:19]
  v_mfma_f32_16x16x32_bf16 v[20:23], v[30:33], v[152:155], v[20:23]
  s_waitcnt vmcnt(8)
  s_add_u32 s94, s57, 4096
  s_mov_b32 m0, s94
  s_add_u32 s95, s56, 589824
  buffer_load_dwordx4 v2, s[8:11], s95 offen offset:0 nt lds
  buffer_load_dwordx4 v3, s[8:11], s95 offen offset:1024 nt lds
  buffer_load_dwordx4 v4, s[8:11], s95 offen offset:2048 nt lds
  buffer_load_dwordx4 v5, s[8:11], s95 offen offset:3072 nt lds
  s_waitcnt vmcnt(24)
  v_and_b32 v26, v60, v11
  v_and_b32 v27, v60, v14
  s_nop 1
  v_mfma_f32_16x16x32_bf16 v[16:19], v[26:29], v[156:159], v[16:19]
  v_mfma_f32_16x16x32_bf16 v[20:23], v[24:27], v[156:159], v[20:23]
  v_and_b32 v32, v61, v11
  v_and_b32 v33, v61, v14
  s_nop 1
  v_mfma_f32_16x16x32_bf16 v[16:19], v[32:35], v[160:163], v[16:19]
  v_mfma_f32_16x16x32_bf16 v[20:23], v[30:33], v[160:163], v[20:23]
  v_and_b32 v26, v62, v11
  v_and_b32 v27, v62, v14
  s_nop 1
  v_mfma_f32_16x16x32_bf16 v[16:19], v[26:29], v[164:167], v[16:19]
  v_mfma_f32_16x16x32_bf16 v[20:23], v[24:27], v[164:167], v[20:23]
  v_and_b32 v32, v63, v11
  v_and_b32 v33, v63, v14
  s_nop 1
  v_mfma_f32_16x16x32_bf16 v[16:19], v[32:35], v[168:171], v[16:19]
  v_mfma_f32_16x16x32_bf16 v[20:23], v[30:33], v[168:171], v[20:23]
  s_waitcnt vmcnt(20)
  v_and_b32 v26, v64, v11
  v_and_b32 v27, v64, v14
  s_nop 1
  v_mfma_f32_16x16x32_bf16 v[16:19], v[26:29], v[172:175], v[16:19]
  v_mfma_f32_16x16x32_bf16 v[20:23], v[24:27], v[172:175], v[20:23]
  v_and_b32 v32, v65, v11
  v_and_b32 v33, v65, v14
  s_nop 1
  v_mfma_f32_16x16x32_bf16 v[16:19], v[32:35], v[176:179], v[16:19]
  v_mfma_f32_16x16x32_bf16 v[20:23], v[30:33], v[176:179], v[20:23]
  v_and_b32 v26, v66, v11
  v_and_b32 v27, v66, v14
  s_nop 1
  v_mfma_f32_16x16x32_bf16 v[16:19], v[26:29], v[180:183], v[16:19]
  v_mfma_f32_16x16x32_bf16 v[20:23], v[24:27], v[180:183], v[20:23]
  v_and_b32 v32, v67, v11
  v_and_b32 v33, v67, v14
  s_nop 1
  v_mfma_f32_16x16x32_bf16 v[16:19], v[32:35], v[184:187], v[16:19]
  v_mfma_f32_16x16x32_bf16 v[20:23], v[30:33], v[184:187], v[20:23]
  s_waitcnt vmcnt(8)
  s_add_u32 s94, s57, 8192
  s_mov_b32 m0, s94
  s_add_u32 s95, s56, 655360
  buffer_load_dwordx4 v2, s[8:11], s95 offen offset:0 nt lds
  buffer_load_dwordx4 v3, s[8:11], s95 offen offset:1024 nt lds
  buffer_load_dwordx4 v4, s[8:11], s95 offen offset:2048 nt lds
  buffer_load_dwordx4 v5, s[8:11], s95 offen offset:3072 nt lds
  s_waitcnt vmcnt(20)
  v_and_b32 v26, v68, v11
  v_and_b32 v27, v68, v14
  s_nop 1
  v_mfma_f32_16x16x32_bf16 v[16:19], v[26:29], v[188:191], v[16:19]
  v_mfma_f32_16x16x32_bf16 v[20:23], v[24:27], v[188:191], v[20:23]
  v_and_b32 v32, v69, v11
  v_and_b32 v33, v69, v14
  s_nop 1
  v_mfma_f32_16x16x32_bf16 v[16:19], v[32:35], v[192:195], v[16:19]
  v_mfma_f32_16x16x32_bf16 v[20:23], v[30:33], v[192:195], v[20:23]
  v_and_b32 v26, v70, v11
  v_and_b32 v27, v70, v14
  s_nop 1
  v_mfma_f32_16x16x32_bf16 v[16:19], v[26:29], v[196:199], v[16:19]
  v_mfma_f32_16x16x32_bf16 v[20:23], v[24:27], v[196:199], v[20:23]
  v_and_b32 v32, v71, v11
  v_and_b32 v33, v71, v14
  s_nop 1
  v_mfma_f32_16x16x32_bf16 v[16:19], v[32:35], v[200:203], v[16:19]
  v_mfma_f32_16x16x32_bf16 v[20:23], v[30:33], v[200:203], v[20:23]
  s_waitcnt vmcnt(16)
  v_and_b32 v26, v72, v11
  v_and_b32 v27, v72, v14
  s_nop 1
  v_mfma_f32_16x16x32_bf16 v[16:19], v[26:29], v[204:207], v[16:19]
  v_mfma_f32_16x16x32_bf16 v[20:23], v[24:27], v[204:207], v[20:23]
  v_and_b32 v32, v73, v11
  v_and_b32 v33, v73, v14
  s_nop 1
  v_mfma_f32_16x16x32_bf16 v[16:19], v[32:35], v[208:211], v[16:19]
  v_mfma_f32_16x16x32_bf16 v[20:23], v[30:33], v[208:211], v[20:23]
  v_and_b32 v26, v74, v11
  v_and_b32 v27, v74, v14
  s_nop 1
  v_mfma_f32_16x16x32_bf16 v[16:19], v[26:29], v[212:215], v[16:19]
  v_mfma_f32_16x16x32_bf16 v[20:23], v[24:27], v[212:215], v[20:23]
  v_and_b32 v32, v75, v11
  v_and_b32 v33, v75, v14
  s_nop 1
  v_mfma_f32_16x16x32_bf16 v[16:19], v[32:35], v[216:219], v[16:19]
  v_mfma_f32_16x16x32_bf16 v[20:23], v[30:33], v[216:219], v[20:23]
  s_waitcnt vmcnt(8)
  s_add_u32 s94, s57, 12288
  s_mov_b32 m0, s94
  s_add_u32 s95, s56, 720896
  buffer_load_dwordx4 v2, s[8:11], s95 offen offset:0 nt lds
  buffer_load_dwordx4 v3, s[8:11], s95 offen offset:1024 nt lds
  buffer_load_dwordx4 v4, s[8:11], s95 offen offset:2048 nt lds
  buffer_load_dwordx4 v5, s[8:11], s95 offen offset:3072 nt lds
  s_waitcnt vmcnt(16)
  v_and_b32 v26, v76, v11
  v_and_b32 v27, v76, v14
  s_nop 1
  v_mfma_f32_16x16x32_bf16 v[16:19], v[26:29], v[220:223], v[16:19]
  v_mfma_f32_16x16x32_bf16 v[20:23], v[24:27], v[220:223], v[20:23]
  v_and_b32 v32, v77, v11
  v_and_b32 v33, v77, v14
  s_nop 1
  v_mfma_f32_16x16x32_bf16 v[16:19], v[32:35], v[224:227], v[16:19]
  v_mfma_f32_16x16x32_bf16 v[20:23], v[30:33], v[224:227], v[20:23]
  v_and_b32 v26, v78, v11
  v_and_b32 v27, v78, v14
  s_nop 1
  v_mfma_f32_16x16x32_bf16 v[16:19], v[26:29], v[228:231], v[16:19]
  v_mfma_f32_16x16x32_bf16 v[20:23], v[24:27], v[228:231], v[20:23]
  v_and_b32 v32, v79, v11
  v_and_b32 v33, v79, v14
  s_nop 1
  v_mfma_f32_16x16x32_bf16 v[16:19], v[32:35], v[232:235], v[16:19]
  v_mfma_f32_16x16x32_bf16 v[20:23], v[30:33], v[232:235], v[20:23]
  s_waitcnt vmcnt(8)
  s_add_u32 s94, s57, 16384
  s_mov_b32 m0, s94
  s_add_u32 s95, s56, 786432
  buffer_load_dwordx4 v2, s[8:11], s95 offen offset:0 nt lds
  buffer_load_dwordx4 v3, s[8:11], s95 offen offset:1024 nt lds
  buffer_load_dwordx4 v4, s[8:11], s95 offen offset:2048 nt lds
  buffer_load_dwordx4 v5, s[8:11], s95 offen offset:3072 nt lds
  s_waitcnt vmcnt(16)
  ds_read_b128 v[92:95], v6 offset:0
  ds_read_b128 v[96:99], v7 offset:0
  ds_read_b128 v[100:103], v8 offset:0
  ds_read_b128 v[104:107], v9 offset:0
  s_waitcnt lgkmcnt(0)
  v_mfma_f32_16x16x32_bf16 v[52:55], v[92:95], v[36:39], 0
  v_mfma_f32_16x16x32_bf16 v[52:55], v[96:99], v[40:43], v[52:55]
  v_mfma_f32_16x16x32_bf16 v[52:55], v[100:103], v[44:47], v[52:55]
  v_mfma_f32_16x16x32_bf16 v[52:55], v[104:107], v[48:51], v[52:55]
  s_waitcnt vmcnt(12)
  ds_read_b128 v[108:111], v6 offset:4096
  ds_read_b128 v[112:115], v7 offset:4096
  ds_read_b128 v[116:119], v8 offset:4096
  ds_read_b128 v[120:123], v9 offset:4096
  s_nop 3
  v_cvt_pk_bf16_f32 v238, v52, v53
  v_cvt_pk_bf16_f32 v239, v54, v55
  v_lshlrev_b32 v52, 16, v238
  v_and_b32 v53, 0xffff0000, v238
  v_lshlrev_b32 v54, 16, v239
  v_and_b32 v55, 0xffff0000, v239
  v_mul_f32 v52, 0x3db504f3, v52
  v_mul_f32 v53, 0x3db504f3, v53
  v_mul_f32 v54, 0x3db504f3, v54
  v_mul_f32 v55, 0x3db504f3, v55
  v_cvt_pk_bf16_f32 v238, v52, v53
  v_cvt_pk_bf16_f32 v239, v54, v55
  v_lshlrev_b32 v52, 16, v238
  v_and_b32 v53, 0xffff0000, v238
  v_lshlrev_b32 v54, 16, v239
  v_and_b32 v55, 0xffff0000, v239
  s_waitcnt lgkmcnt(0)
  v_mfma_f32_16x16x32_bf16 v[56:59], v[108:111], v[36:39], 0
  v_mfma_f32_16x16x32_bf16 v[56:59], v[112:115], v[40:43], v[56:59]
  v_mfma_f32_16x16x32_bf16 v[56:59], v[116:119], v[44:47], v[56:59]
  v_mfma_f32_16x16x32_bf16 v[56:59], v[120:123], v[48:51], v[56:59]
  s_waitcnt vmcnt(8)
  s_add_u32 s94, s57, 20480
  s_mov_b32 m0, s94
  s_add_u32 s95, s56, 851968
  buffer_load_dwordx4 v2, s[8:11], s95 offen offset:0 nt lds
  buffer_load_dwordx4 v3, s[8:11], s95 offen offset:1024 nt lds
  buffer_load_dwordx4 v4, s[8:11], s95 offen offset:2048 nt lds
  buffer_load_dwordx4 v5, s[8:11], s95 offen offset:3072 nt lds
  s_waitcnt vmcnt(12)
  ds_read_b128 v[92:95], v6 offset:8192
  ds_read_b128 v[96:99], v7 offset:8192
  ds_read_b128 v[100:103], v8 offset:8192
  ds_read_b128 v[104:107], v9 offset:8192
  s_nop 3
  v_cvt_pk_bf16_f32 v238, v56, v57
  v_cvt_pk_bf16_f32 v239, v58, v59
  v_lshlrev_b32 v56, 16, v238
  v_and_b32 v57, 0xffff0000, v238
  v_lshlrev_b32 v58, 16, v239
  v_and_b32 v59, 0xffff0000, v239
  v_mul_f32 v56, 0x3db504f3, v56
  v_mul_f32 v57, 0x3db504f3, v57
  v_mul_f32 v58, 0x3db504f3, v58
  v_mul_f32 v59, 0x3db504f3, v59
  v_cvt_pk_bf16_f32 v238, v56, v57
  v_cvt_pk_bf16_f32 v239, v58, v59
  v_lshlrev_b32 v56, 16, v238
  v_and_b32 v57, 0xffff0000, v238
  v_lshlrev_b32 v58, 16, v239
  v_and_b32 v59, 0xffff0000, v239
  s_waitcnt lgkmcnt(0)
  v_mfma_f32_16x16x32_bf16 v[60:63], v[92:95], v[36:39], 0
  v_mfma_f32_16x16x32_bf16 v[60:63], v[96:99], v[40:43], v[60:63]
  v_mfma_f32_16x16x32_bf16 v[60:63], v[100:103], v[44:47], v[60:63]
  v_mfma_f32_16x16x32_bf16 v[60:63], v[104:107], v[48:51], v[60:63]
  s_waitcnt vmcnt(8)
  s_add_u32 s94, s57, 24576
  s_mov_b32 m0, s94
  s_add_u32 s95, s56, 917504
  buffer_load_dwordx4 v2, s[8:11], s95 offen offset:0 nt lds
  buffer_load_dwordx4 v3, s[8:11], s95 offen offset:1024 nt lds
  buffer_load_dwordx4 v4, s[8:11], s95 offen offset:2048 nt lds
  buffer_load_dwordx4 v5, s[8:11], s95 offen offset:3072 nt lds
  s_waitcnt vmcnt(12)
  ds_read_b128 v[108:111], v6 offset:12288
  ds_read_b128 v[112:115], v7 offset:12288
  ds_read_b128 v[116:119], v8 offset:12288
  ds_read_b128 v[120:123], v9 offset:12288
  s_nop 3
  v_cvt_pk_bf16_f32 v238, v60, v61
  v_cvt_pk_bf16_f32 v239, v62, v63
  v_lshlrev_b32 v60, 16, v238
  v_and_b32 v61, 0xffff0000, v238
  v_lshlrev_b32 v62, 16, v239
  v_and_b32 v63, 0xffff0000, v239
  v_mul_f32 v60, 0x3db504f3, v60
  v_mul_f32 v61, 0x3db504f3, v61
  v_mul_f32 v62, 0x3db504f3, v62
  v_mul_f32 v63, 0x3db504f3, v63
  v_cvt_pk_bf16_f32 v238, v60, v61
  v_cvt_pk_bf16_f32 v239, v62, v63
  v_lshlrev_b32 v60, 16, v238
  v_and_b32 v61, 0xffff0000, v238
  v_lshlrev_b32 v62, 16, v239
  v_and_b32 v63, 0xffff0000, v239
  s_waitcnt lgkmcnt(0)
  v_mfma_f32_16x16x32_bf16 v[64:67], v[108:111], v[36:39], 0
  v_mfma_f32_16x16x32_bf16 v[64:67], v[112:115], v[40:43], v[64:67]
  v_mfma_f32_16x16x32_bf16 v[64:67], v[116:119], v[44:47], v[64:67]
  v_mfma_f32_16x16x32_bf16 v[64:67], v[120:123], v[48:51], v[64:67]
  s_waitcnt vmcnt(8)
  s_add_u32 s94, s57, 28672
  s_mov_b32 m0, s94
  s_add_u32 s95, s56, 983040
  buffer_load_dwordx4 v2, s[8:11], s95 offen offset:0 nt lds
  buffer_load_dwordx4 v3, s[8:11], s95 offen offset:1024 nt lds
  buffer_load_dwordx4 v4, s[8:11], s95 offen offset:2048 nt lds
  buffer_load_dwordx4 v5, s[8:11], s95 offen offset:3072 nt lds
  s_waitcnt vmcnt(12)
  ds_read_b128 v[92:95], v6 offset:16384
  ds_read_b128 v[96:99], v7 offset:16384
  ds_read_b128 v[100:103], v8 offset:16384
  ds_read_b128 v[104:107], v9 offset:16384
  s_nop 3
  v_cvt_pk_bf16_f32 v238, v64, v65
  v_cvt_pk_bf16_f32 v239, v66, v67
  v_lshlrev_b32 v64, 16, v238
  v_and_b32 v65, 0xffff0000, v238
  v_lshlrev_b32 v66, 16, v239
  v_and_b32 v67, 0xffff0000, v239
  v_mul_f32 v64, 0x3db504f3, v64
  v_mul_f32 v65, 0x3db504f3, v65
  v_mul_f32 v66, 0x3db504f3, v66
  v_mul_f32 v67, 0x3db504f3, v67
  v_cvt_pk_bf16_f32 v238, v64, v65
  v_cvt_pk_bf16_f32 v239, v66, v67
  v_lshlrev_b32 v64, 16, v238
  v_and_b32 v65, 0xffff0000, v238
  v_lshlrev_b32 v66, 16, v239
  v_and_b32 v67, 0xffff0000, v239
  s_waitcnt lgkmcnt(0)
  v_mfma_f32_16x16x32_bf16 v[68:71], v[92:95], v[36:39], 0
  v_mfma_f32_16x16x32_bf16 v[68:71], v[96:99], v[40:43], v[68:71]
  v_mfma_f32_16x16x32_bf16 v[68:71], v[100:103], v[44:47], v[68:71]
  v_mfma_f32_16x16x32_bf16 v[68:71], v[104:107], v[48:51], v[68:71]
  s_waitcnt vmcnt(8)
  s_add_u32 s95, s56, 458752
  buffer_load_dwordx4 v[124:127], v10, s[12:15], s95 offen offset:0 nt
  buffer_load_dwordx4 v[128:131], v10, s[12:15], s95 offen offset:256 nt
  buffer_load_dwordx4 v[132:135], v10, s[12:15], s95 offen offset:512 nt
  buffer_load_dwordx4 v[136:139], v10, s[12:15], s95 offen offset:768 nt
  s_waitcnt vmcnt(12)
  ds_read_b128 v[108:111], v6 offset:20480
  ds_read_b128 v[112:115], v7 offset:20480
  ds_read_b128 v[116:119], v8 offset:20480
  ds_read_b128 v[120:123], v9 offset:20480
  s_nop 3
  v_cvt_pk_bf16_f32 v238, v68, v69
  v_cvt_pk_bf16_f32 v239, v70, v71
  v_lshlrev_b32 v68, 16, v238
  v_and_b32 v69, 0xffff0000, v238
  v_lshlrev_b32 v70, 16, v239
  v_and_b32 v71, 0xffff0000, v239
  v_mul_f32 v68, 0x3db504f3, v68
  v_mul_f32 v69, 0x3db504f3, v69
  v_mul_f32 v70, 0x3db504f3, v70
  v_mul_f32 v71, 0x3db504f3, v71
  v_cvt_pk_bf16_f32 v238, v68, v69
  v_cvt_pk_bf16_f32 v239, v70, v71
  v_lshlrev_b32 v68, 16, v238
  v_and_b32 v69, 0xffff0000, v238
  v_lshlrev_b32 v70, 16, v239
  v_and_b32 v71, 0xffff0000, v239
  s_waitcnt lgkmcnt(0)
  v_mfma_f32_16x16x32_bf16 v[72:75], v[108:111], v[36:39], 0
  v_mfma_f32_16x16x32_bf16 v[72:75], v[112:115], v[40:43], v[72:75]
  v_mfma_f32_16x16x32_bf16 v[72:75], v[116:119], v[44:47], v[72:75]
  v_mfma_f32_16x16x32_bf16 v[72:75], v[120:123], v[48:51], v[72:75]
  s_waitcnt vmcnt(8)
  s_add_u32 s95, s56, 524288
  buffer_load_dwordx4 v[140:143], v10, s[12:15], s95 offen offset:0 nt
  buffer_load_dwordx4 v[144:147], v10, s[12:15], s95 offen offset:256 nt
  buffer_load_dwordx4 v[148:151], v10, s[12:15], s95 offen offset:512 nt
  buffer_load_dwordx4 v[152:155], v10, s[12:15], s95 offen offset:768 nt
  s_waitcnt vmcnt(12)
  ds_read_b128 v[92:95], v6 offset:24576
  ds_read_b128 v[96:99], v7 offset:24576
  ds_read_b128 v[100:103], v8 offset:24576
  ds_read_b128 v[104:107], v9 offset:24576
  s_nop 3
  v_cvt_pk_bf16_f32 v238, v72, v73
  v_cvt_pk_bf16_f32 v239, v74, v75
  v_lshlrev_b32 v72, 16, v238
  v_and_b32 v73, 0xffff0000, v238
  v_lshlrev_b32 v74, 16, v239
  v_and_b32 v75, 0xffff0000, v239
  v_mul_f32 v72, 0x3db504f3, v72
  v_mul_f32 v73, 0x3db504f3, v73
  v_mul_f32 v74, 0x3db504f3, v74
  v_mul_f32 v75, 0x3db504f3, v75
  v_cvt_pk_bf16_f32 v238, v72, v73
  v_cvt_pk_bf16_f32 v239, v74, v75
  v_lshlrev_b32 v72, 16, v238
  v_and_b32 v73, 0xffff0000, v238
  v_lshlrev_b32 v74, 16, v239
  v_and_b32 v75, 0xffff0000, v239
  s_waitcnt lgkmcnt(0)
  v_mfma_f32_16x16x32_bf16 v[76:79], v[92:95], v[36:39], 0
  v_mfma_f32_16x16x32_bf16 v[76:79], v[96:99], v[40:43], v[76:79]
  v_mfma_f32_16x16x32_bf16 v[76:79], v[100:103], v[44:47], v[76:79]
  v_mfma_f32_16x16x32_bf16 v[76:79], v[104:107], v[48:51], v[76:79]
  s_waitcnt vmcnt(8)
  s_add_u32 s95, s56, 589824
  buffer_load_dwordx4 v[156:159], v10, s[12:15], s95 offen offset:0 nt
  buffer_load_dwordx4 v[160:163], v10, s[12:15], s95 offen offset:256 nt
  buffer_load_dwordx4 v[164:167], v10, s[12:15], s95 offen offset:512 nt
  buffer_load_dwordx4 v[168:171], v10, s[12:15], s95 offen offset:768 nt
  s_waitcnt vmcnt(12)
  ds_read_b128 v[108:111], v6 offset:28672
  ds_read_b128 v[112:115], v7 offset:28672
  ds_read_b128 v[116:119], v8 offset:28672
  ds_read_b128 v[120:123], v9 offset:28672
  s_nop 3
  v_cvt_pk_bf16_f32 v238, v76, v77
  v_cvt_pk_bf16_f32 v239, v78, v79
  v_lshlrev_b32 v76, 16, v238
  v_and_b32 v77, 0xffff0000, v238
  v_lshlrev_b32 v78, 16, v239
  v_and_b32 v79, 0xffff0000, v239
  v_mul_f32 v76, 0x3db504f3, v76
  v_mul_f32 v77, 0x3db504f3, v77
  v_mul_f32 v78, 0x3db504f3, v78
  v_mul_f32 v79, 0x3db504f3, v79
  v_cvt_pk_bf16_f32 v238, v76, v77
  v_cvt_pk_bf16_f32 v239, v78, v79
  v_lshlrev_b32 v76, 16, v238
  v_and_b32 v77, 0xffff0000, v238
  v_lshlrev_b32 v78, 16, v239
  v_and_b32 v79, 0xffff0000, v239
  s_waitcnt lgkmcnt(0)
  v_mfma_f32_16x16x32_bf16 v[84:87], v[108:111], v[36:39], 0
  v_mfma_f32_16x16x32_bf16 v[84:87], v[112:115], v[40:43], v[84:87]
  v_mfma_f32_16x16x32_bf16 v[84:87], v[116:119], v[44:47], v[84:87]
  v_mfma_f32_16x16x32_bf16 v[84:87], v[120:123], v[48:51], v[84:87]
  s_nop 7
  s_nop 3
  v_cvt_pk_bf16_f32 v238, v84, v85
  v_cvt_pk_bf16_f32 v239, v86, v87
  v_lshlrev_b32 v84, 16, v238
  v_and_b32 v85, 0xffff0000, v238
  v_lshlrev_b32 v86, 16, v239
  v_and_b32 v87, 0xffff0000, v239
  v_mul_f32 v84, 0x3db504f3, v84
  v_mul_f32 v85, 0x3db504f3, v85
  v_mul_f32 v86, 0x3db504f3, v86
  v_mul_f32 v87, 0x3db504f3, v87
  v_cvt_pk_bf16_f32 v238, v84, v85
  v_cvt_pk_bf16_f32 v239, v86, v87
  v_lshlrev_b32 v84, 16, v238
  v_and_b32 v85, 0xffff0000, v238
  v_lshlrev_b32 v86, 16, v239
  v_and_b32 v87, 0xffff0000, v239
  v_max3_f32 v238, v80, v52, v56
  v_max3_f32 v239, v81, v53, v57
  v_max3_f32 v240, v82, v54, v58
  v_max3_f32 v241, v83, v55, v59
  v_max3_f32 v238, v238, v60, v64
  v_max3_f32 v239, v239, v61, v65
  v_max3_f32 v240, v240, v62, v66
  v_max3_f32 v241, v241, v63, v67
  v_max3_f32 v238, v238, v68, v72
  v_max3_f32 v239, v239, v69, v73
  v_max3_f32 v240, v240, v70, v74
  v_max3_f32 v241, v241, v71, v75
  v_max3_f32 v238, v238, v76, v84
  v_max3_f32 v239, v239, v77, v85
  v_max3_f32 v240, v240, v78, v86
  v_max3_f32 v241, v241, v79, v87
  v_max3_f32 v242, v238, v239, v240
  v_max_f32 v242, v242, v241
  v_mov_b32 v238, v242
  s_nop 1
  v_permlane16_swap_b32 v242, v238
  s_nop 0
  v_max_f32 v242, v242, v238
  v_mov_b32 v238, v242
  s_nop 1
  v_permlane32_swap_b32 v242, v238
  s_nop 0
  v_max_f32 v242, v242, v238
  v_max_f32 v242, v242, v15
  v_sub_f32 v243, v15, v242
  v_mul_f32 v243, s68, v243
  v_exp_f32 v243, v243
  v_mov_b32 v15, v242
  v_mul_f32 v238, 0xbfb8aa3b, v242
  v_readlane_b32 s64, v243, 0
  v_readlane_b32 s65, v243, 1
  v_readlane_b32 s66, v243, 2
  v_readlane_b32 s67, v243, 3
  v_mov_b32 v244, s68
  v_fma_f32 v80, v80, v244, v238
  v_fma_f32 v81, v81, v244, v238
  v_fma_f32 v82, v82, v244, v238
  v_fma_f32 v83, v83, v244, v238
  v_fma_f32 v52, v52, v244, v238
  v_fma_f32 v53, v53, v244, v238
  v_fma_f32 v54, v54, v244, v238
  v_fma_f32 v55, v55, v244, v238
  v_fma_f32 v56, v56, v244, v238
  v_fma_f32 v57, v57, v244, v238
  v_fma_f32 v58, v58, v244, v238
  v_fma_f32 v59, v59, v244, v238
  v_fma_f32 v60, v60, v244, v238
  v_fma_f32 v61, v61, v244, v238
  v_fma_f32 v62, v62, v244, v238
  v_fma_f32 v63, v63, v244, v238
  v_fma_f32 v64, v64, v244, v238
  v_fma_f32 v65, v65, v244, v238
  v_fma_f32 v66, v66, v244, v238
  v_fma_f32 v67, v67, v244, v238
  v_fma_f32 v68, v68, v244, v238
  v_fma_f32 v69, v69, v244, v238
  v_fma_f32 v70, v70, v244, v238
  v_fma_f32 v71, v71, v244, v238
  v_fma_f32 v72, v72, v244, v238
  v_fma_f32 v73, v73, v244, v238
  v_fma_f32 v74, v74, v244, v238
  v_fma_f32 v75, v75, v244, v238
  v_fma_f32 v76, v76, v244, v238
  v_fma_f32 v77, v77, v244, v238
  v_fma_f32 v78, v78, v244, v238
  v_fma_f32 v79, v79, v244, v238
  v_fma_f32 v84, v84, v244, v238
  v_fma_f32 v85, v85, v244, v238
  v_fma_f32 v86, v86, v244, v238
  v_fma_f32 v87, v87, v244, v238
  v_exp_f32 v80, v80
  v_exp_f32 v81, v81
  v_exp_f32 v82, v82
  v_exp_f32 v83, v83
  v_exp_f32 v52, v52
  v_exp_f32 v53, v53
  v_exp_f32 v54, v54
  v_exp_f32 v55, v55
  v_exp_f32 v56, v56
  v_exp_f32 v57, v57
  v_exp_f32 v58, v58
  v_exp_f32 v59, v59
  v_exp_f32 v60, v60
  v_exp_f32 v61, v61
  v_exp_f32 v62, v62
  v_exp_f32 v63, v63
  v_exp_f32 v64, v64
  v_exp_f32 v65, v65
  v_exp_f32 v66, v66
  v_exp_f32 v67, v67
  v_exp_f32 v68, v68
  v_exp_f32 v69, v69
  v_exp_f32 v70, v70
  v_exp_f32 v71, v71
  v_exp_f32 v72, v72
  v_exp_f32 v73, v73
  v_exp_f32 v74, v74
  v_exp_f32 v75, v75
  v_exp_f32 v76, v76
  v_exp_f32 v77, v77
  v_exp_f32 v78, v78
  v_exp_f32 v79, v79
  v_exp_f32 v84, v84
  v_exp_f32 v85, v85
  v_exp_f32 v86, v86
  v_exp_f32 v87, v87
  v_add_f32 v239, v80, v52
  v_add_f32 v240, v81, v53
  v_add_f32 v241, v82, v54
  v_add_f32 v242, v83, v55
  v_add_f32 v239, v239, v56
  v_add_f32 v240, v240, v57
  v_add_f32 v241, v241, v58
  v_add_f32 v242, v242, v59
  v_add_f32 v239, v239, v60
  v_add_f32 v240, v240, v61
  v_add_f32 v241, v241, v62
  v_add_f32 v242, v242, v63
  v_add_f32 v239, v239, v64
  v_add_f32 v240, v240, v65
  v_add_f32 v241, v241, v66
  v_add_f32 v242, v242, v67
  v_add_f32 v239, v239, v68
  v_add_f32 v240, v240, v69
  v_add_f32 v241, v241, v70
  v_add_f32 v242, v242, v71
  v_add_f32 v239, v239, v72
  v_add_f32 v240, v240, v73
  v_add_f32 v241, v241, v74
  v_add_f32 v242, v242, v75
  v_add_f32 v239, v239, v76
  v_add_f32 v240, v240, v77
  v_add_f32 v241, v241, v78
  v_add_f32 v242, v242, v79
  v_add_f32 v239, v239, v84
  v_add_f32 v240, v240, v85
  v_add_f32 v241, v241, v86
  v_add_f32 v242, v242, v87
  v_add_f32 v239, v239, v240
  v_add_f32 v241, v241, v242
  v_add_f32 v239, v239, v241
  v_mov_b32 v240, v239
  s_nop 1
  v_permlane16_swap_b32 v239, v240
  s_nop 0
  v_add_f32 v239, v239, v240
  v_mov_b32 v240, v239
  s_nop 1
  v_permlane32_swap_b32 v239, v240
  s_nop 0
  v_add_f32 v239, v239, v240
  v_fma_f32 v236, v236, v243, v239
  v_mov_b32 v241, v236
  s_lshl_b32 s92, s62, 5
  s_add_u32 s92, s92, 158720
  v_lshl_add_u32 v242, v0, 3, s92
  v_mov_b32 v240, v15
  s_mov_b64 exec, 15
  ds_write_b64 v242, v[240:241]
  s_mov_b64 exec, -1
  v_mov_b32 v244, 158924
  v_mov_b32 v245, 1
  s_waitcnt lgkmcnt(0)
  s_mov_b64 exec, 1
  ds_add_u32 v244, v245
  s_mov_b64 exec, -1
  v_mul_f32 v16, s64, v16
  v_mul_f32 v17, s65, v17
  v_mul_f32 v18, s66, v18
  v_mul_f32 v19, s67, v19
  v_mul_f32 v20, s64, v20
  v_mul_f32 v21, s65, v21
  v_mul_f32 v22, s66, v22
  v_mul_f32 v23, s67, v23
  v_cvt_pk_bf16_f32 v80, v80, v80
  v_cvt_pk_bf16_f32 v81, v81, v81
  v_cvt_pk_bf16_f32 v82, v82, v82
  v_cvt_pk_bf16_f32 v83, v83, v83
  v_cvt_pk_bf16_f32 v52, v52, v52
  v_cvt_pk_bf16_f32 v53, v53, v53
  v_cvt_pk_bf16_f32 v54, v54, v54
  v_cvt_pk_bf16_f32 v55, v55, v55
  v_cvt_pk_bf16_f32 v56, v56, v56
  v_cvt_pk_bf16_f32 v57, v57, v57
  v_cvt_pk_bf16_f32 v58, v58, v58
  v_cvt_pk_bf16_f32 v59, v59, v59
  v_cvt_pk_bf16_f32 v60, v60, v60
  v_cvt_pk_bf16_f32 v61, v61, v61
  v_cvt_pk_bf16_f32 v62, v62, v62
  v_cvt_pk_bf16_f32 v63, v63, v63
  v_cvt_pk_bf16_f32 v64, v64, v64
  v_cvt_pk_bf16_f32 v65, v65, v65
  v_cvt_pk_bf16_f32 v66, v66, v66
  v_cvt_pk_bf16_f32 v67, v67, v67
  v_cvt_pk_bf16_f32 v68, v68, v68
  v_cvt_pk_bf16_f32 v69, v69, v69
  v_cvt_pk_bf16_f32 v70, v70, v70
  v_cvt_pk_bf16_f32 v71, v71, v71
  v_cvt_pk_bf16_f32 v72, v72, v72
  v_cvt_pk_bf16_f32 v73, v73, v73
  v_cvt_pk_bf16_f32 v74, v74, v74
  v_cvt_pk_bf16_f32 v75, v75, v75
  v_cvt_pk_bf16_f32 v76, v76, v76
  v_cvt_pk_bf16_f32 v77, v77, v77
  v_cvt_pk_bf16_f32 v78, v78, v78
  v_cvt_pk_bf16_f32 v79, v79, v79
  v_cvt_pk_bf16_f32 v84, v84, v84
  v_cvt_pk_bf16_f32 v85, v85, v85
  v_cvt_pk_bf16_f32 v86, v86, v86
  v_cvt_pk_bf16_f32 v87, v87, v87
  s_waitcnt vmcnt(8)
  s_add_u32 s95, s56, 655360
  buffer_load_dwordx4 v[172:175], v10, s[12:15], s95 offen offset:0 nt
  buffer_load_dwordx4 v[176:179], v10, s[12:15], s95 offen offset:256 nt
  buffer_load_dwordx4 v[180:183], v10, s[12:15], s95 offen offset:512 nt
  buffer_load_dwordx4 v[184:187], v10, s[12:15], s95 offen offset:768 nt
  s_waitcnt vmcnt(12)
  v_and_b32 v26, v80, v11
  v_and_b32 v27, v80, v14
  s_nop 1
  v_mfma_f32_16x16x32_bf16 v[16:19], v[26:29], v[124:127], v[16:19]
  v_mfma_f32_16x16x32_bf16 v[20:23], v[24:27], v[124:127], v[20:23]
  v_and_b32 v32, v81, v11
  v_and_b32 v33, v81, v14
  s_nop 1
  v_mfma_f32_16x16x32_bf16 v[16:19], v[32:35], v[128:131], v[16:19]
  v_mfma_f32_16x16x32_bf16 v[20:23], v[30:33], v[128:131], v[20:23]
  v_and_b32 v26, v82, v11
  v_and_b32 v27, v82, v14
  s_nop 1
  v_mfma_f32_16x16x32_bf16 v[16:19], v[26:29], v[132:135], v[16:19]
  v_mfma_f32_16x16x32_bf16 v[20:23], v[24:27], v[132:135], v[20:23]
  v_and_b32 v32, v83, v11
  v_and_b32 v33, v83, v14
  s_nop 1
  v_mfma_f32_16x16x32_bf16 v[16:19], v[32:35], v[136:139], v[16:19]
  v_mfma_f32_16x16x32_bf16 v[20:23], v[30:33], v[136:139], v[20:23]
  s_waitcnt vmcnt(8)
  s_add_u32 s95, s56, 720896
  buffer_load_dwordx4 v[188:191], v10, s[12:15], s95 offen offset:0 nt
  buffer_load_dwordx4 v[192:195], v10, s[12:15], s95 offen offset:256 nt
  buffer_load_dwordx4 v[196:199], v10, s[12:15], s95 offen offset:512 nt
  buffer_load_dwordx4 v[200:203], v10, s[12:15], s95 offen offset:768 nt
  s_waitcnt vmcnt(12)
  v_and_b32 v26, v52, v11
  v_and_b32 v27, v52, v14
  s_nop 1
  v_mfma_f32_16x16x32_bf16 v[16:19], v[26:29], v[140:143], v[16:19]
  v_mfma_f32_16x16x32_bf16 v[20:23], v[24:27], v[140:143], v[20:23]
  v_and_b32 v32, v53, v11
  v_and_b32 v33, v53, v14
  s_nop 1
  v_mfma_f32_16x16x32_bf16 v[16:19], v[32:35], v[144:147], v[16:19]
  v_mfma_f32_16x16x32_bf16 v[20:23], v[30:33], v[144:147], v[20:23]
  v_and_b32 v26, v54, v11
  v_and_b32 v27, v54, v14
  s_nop 1
  v_mfma_f32_16x16x32_bf16 v[16:19], v[26:29], v[148:151], v[16:19]
  v_mfma_f32_16x16x32_bf16 v[20:23], v[24:27], v[148:151], v[20:23]
  v_and_b32 v32, v55, v11
  v_and_b32 v33, v55, v14
  s_nop 1
  v_mfma_f32_16x16x32_bf16 v[16:19], v[32:35], v[152:155], v[16:19]
  v_mfma_f32_16x16x32_bf16 v[20:23], v[30:33], v[152:155], v[20:23]
  s_waitcnt vmcnt(8)
  s_add_u32 s95, s56, 786432
  buffer_load_dwordx4 v[204:207], v10, s[12:15], s95 offen offset:0 nt
  buffer_load_dwordx4 v[208:211], v10, s[12:15], s95 offen offset:256 nt
  buffer_load_dwordx4 v[212:215], v10, s[12:15], s95 offen offset:512 nt
  buffer_load_dwordx4 v[216:219], v10, s[12:15], s95 offen offset:768 nt
  s_waitcnt vmcnt(12)
  v_and_b32 v26, v56, v11
  v_and_b32 v27, v56, v14
  s_nop 1
  v_mfma_f32_16x16x32_bf16 v[16:19], v[26:29], v[156:159], v[16:19]
  v_mfma_f32_16x16x32_bf16 v[20:23], v[24:27], v[156:159], v[20:23]
  v_and_b32 v32, v57, v11
  v_and_b32 v33, v57, v14
  s_nop 1
  v_mfma_f32_16x16x32_bf16 v[16:19], v[32:35], v[160:163], v[16:19]
  v_mfma_f32_16x16x32_bf16 v[20:23], v[30:33], v[160:163], v[20:23]
  v_and_b32 v26, v58, v11
  v_and_b32 v27, v58, v14
  s_nop 1
  v_mfma_f32_16x16x32_bf16 v[16:19], v[26:29], v[164:167], v[16:19]
  v_mfma_f32_16x16x32_bf16 v[20:23], v[24:27], v[164:167], v[20:23]
  v_and_b32 v32, v59, v11
  v_and_b32 v33, v59, v14
  s_nop 1
  v_mfma_f32_16x16x32_bf16 v[16:19], v[32:35], v[168:171], v[16:19]
  v_mfma_f32_16x16x32_bf16 v[20:23], v[30:33], v[168:171], v[20:23]
  s_waitcnt vmcnt(8)
  s_add_u32 s95, s56, 851968
  buffer_load_dwordx4 v[220:223], v10, s[12:15], s95 offen offset:0 nt
  buffer_load_dwordx4 v[224:227], v10, s[12:15], s95 offen offset:256 nt
  buffer_load_dwordx4 v[228:231], v10, s[12:15], s95 offen offset:512 nt
  buffer_load_dwordx4 v[232:235], v10, s[12:15], s95 offen offset:768 nt
  s_waitcnt vmcnt(12)
  v_and_b32 v26, v60, v11
  v_and_b32 v27, v60, v14
  s_nop 1
  v_mfma_f32_16x16x32_bf16 v[16:19], v[26:29], v[172:175], v[16:19]
  v_mfma_f32_16x16x32_bf16 v[20:23], v[24:27], v[172:175], v[20:23]
  v_and_b32 v32, v61, v11
  v_and_b32 v33, v61, v14
  s_nop 1
  v_mfma_f32_16x16x32_bf16 v[16:19], v[32:35], v[176:179], v[16:19]
  v_mfma_f32_16x16x32_bf16 v[20:23], v[30:33], v[176:179], v[20:23]
  v_and_b32 v26, v62, v11
  v_and_b32 v27, v62, v14
  s_nop 1
  v_mfma_f32_16x16x32_bf16 v[16:19], v[26:29], v[180:183], v[16:19]
  v_mfma_f32_16x16x32_bf16 v[20:23], v[24:27], v[180:183], v[20:23]
  v_and_b32 v32, v63, v11
  v_and_b32 v33, v63, v14
  s_nop 1
  v_mfma_f32_16x16x32_bf16 v[16:19], v[32:35], v[184:187], v[16:19]
  v_mfma_f32_16x16x32_bf16 v[20:23], v[30:33], v[184:187], v[20:23]
  s_waitcnt vmcnt(8)
  s_add_u32 s95, s56, 917504
  buffer_load_dwordx4 v[124:127], v10, s[12:15], s95 offen offset:0 nt
  buffer_load_dwordx4 v[128:131], v10, s[12:15], s95 offen offset:256 nt
  buffer_load_dwordx4 v[132:135], v10, s[12:15], s95 offen offset:512 nt
  buffer_load_dwordx4 v[136:139], v10, s[12:15], s95 offen offset:768 nt
  s_waitcnt vmcnt(12)
  v_and_b32 v26, v64, v11
  v_and_b32 v27, v64, v14
  s_nop 1
  v_mfma_f32_16x16x32_bf16 v[16:19], v[26:29], v[188:191], v[16:19]
  v_mfma_f32_16x16x32_bf16 v[20:23], v[24:27], v[188:191], v[20:23]
  v_and_b32 v32, v65, v11
  v_and_b32 v33, v65, v14
  s_nop 1
  v_mfma_f32_16x16x32_bf16 v[16:19], v[32:35], v[192:195], v[16:19]
  v_mfma_f32_16x16x32_bf16 v[20:23], v[30:33], v[192:195], v[20:23]
  v_and_b32 v26, v66, v11
  v_and_b32 v27, v66, v14
  s_nop 1
  v_mfma_f32_16x16x32_bf16 v[16:19], v[26:29], v[196:199], v[16:19]
  v_mfma_f32_16x16x32_bf16 v[20:23], v[24:27], v[196:199], v[20:23]
  v_and_b32 v32, v67, v11
  v_and_b32 v33, v67, v14
  s_nop 1
  v_mfma_f32_16x16x32_bf16 v[16:19], v[32:35], v[200:203], v[16:19]
  v_mfma_f32_16x16x32_bf16 v[20:23], v[30:33], v[200:203], v[20:23]
  s_waitcnt vmcnt(8)
  s_add_u32 s95, s56, 983040
  buffer_load_dwordx4 v[140:143], v10, s[12:15], s95 offen offset:0 nt
  buffer_load_dwordx4 v[144:147], v10, s[12:15], s95 offen offset:256 nt
  buffer_load_dwordx4 v[148:151], v10, s[12:15], s95 offen offset:512 nt
  buffer_load_dwordx4 v[152:155], v10, s[12:15], s95 offen offset:768 nt
  s_waitcnt vmcnt(12)
  v_and_b32 v26, v68, v11
  v_and_b32 v27, v68, v14
  s_nop 1
  v_mfma_f32_16x16x32_bf16 v[16:19], v[26:29], v[204:207], v[16:19]
  v_mfma_f32_16x16x32_bf16 v[20:23], v[24:27], v[204:207], v[20:23]
  v_and_b32 v32, v69, v11
  v_and_b32 v33, v69, v14
  s_nop 1
  v_mfma_f32_16x16x32_bf16 v[16:19], v[32:35], v[208:211], v[16:19]
  v_mfma_f32_16x16x32_bf16 v[20:23], v[30:33], v[208:211], v[20:23]
  v_and_b32 v26, v70, v11
  v_and_b32 v27, v70, v14
  s_nop 1
  v_mfma_f32_16x16x32_bf16 v[16:19], v[26:29], v[212:215], v[16:19]
  v_mfma_f32_16x16x32_bf16 v[20:23], v[24:27], v[212:215], v[20:23]
  v_and_b32 v32, v71, v11
  v_and_b32 v33, v71, v14
  s_nop 1
  v_mfma_f32_16x16x32_bf16 v[16:19], v[32:35], v[216:219], v[16:19]
  v_mfma_f32_16x16x32_bf16 v[20:23], v[30:33], v[216:219], v[20:23]
  s_lshl_b32 s92, s62, 4
  s_add_u32 s92, s92, 158848
  v_mov_b32 v240, s92
  v_lshlrev_b32 v241, 3, v0
  v_add_u32 v241, s57, v241
  s_waitcnt vmcnt(8)
  v_and_b32 v26, v72, v11
  v_and_b32 v27, v72, v14
  s_nop 1
  v_mfma_f32_16x16x32_bf16 v[16:19], v[26:29], v[220:223], v[16:19]
  v_mfma_f32_16x16x32_bf16 v[20:23], v[24:27], v[220:223], v[20:23]
  v_and_b32 v32, v73, v11
  v_and_b32 v33, v73, v14
  s_nop 1
  v_mfma_f32_16x16x32_bf16 v[16:19], v[32:35], v[224:227], v[16:19]
  v_mfma_f32_16x16x32_bf16 v[20:23], v[30:33], v[224:227], v[20:23]
  v_and_b32 v26, v74, v11
  v_and_b32 v27, v74, v14
  s_nop 1
  v_mfma_f32_16x16x32_bf16 v[16:19], v[26:29], v[228:231], v[16:19]
  v_mfma_f32_16x16x32_bf16 v[20:23], v[24:27], v[228:231], v[20:23]
  v_and_b32 v32, v75, v11
  v_and_b32 v33, v75, v14
  s_nop 1
  v_mfma_f32_16x16x32_bf16 v[16:19], v[32:35], v[232:235], v[16:19]
  v_mfma_f32_16x16x32_bf16 v[20:23], v[30:33], v[232:235], v[20:23]
  s_waitcnt vmcnt(4)
  v_and_b32 v26, v76, v11
  v_and_b32 v27, v76, v14
  s_nop 1
  v_mfma_f32_16x16x32_bf16 v[16:19], v[26:29], v[124:127], v[16:19]
  v_mfma_f32_16x16x32_bf16 v[20:23], v[24:27], v[124:127], v[20:23]
  v_and_b32 v32, v77, v11
  v_and_b32 v33, v77, v14
  s_nop 1
  v_mfma_f32_16x16x32_bf16 v[16:19], v[32:35], v[128:131], v[16:19]
  v_mfma_f32_16x16x32_bf16 v[20:23], v[30:33], v[128:131], v[20:23]
  v_and_b32 v26, v78, v11
  v_and_b32 v27, v78, v14
  s_nop 1
  v_mfma_f32_16x16x32_bf16 v[16:19], v[26:29], v[132:135], v[16:19]
  v_mfma_f32_16x16x32_bf16 v[20:23], v[24:27], v[132:135], v[20:23]
  v_and_b32 v32, v79, v11
  v_and_b32 v33, v79, v14
  s_nop 1
  v_mfma_f32_16x16x32_bf16 v[16:19], v[32:35], v[136:139], v[16:19]
  v_mfma_f32_16x16x32_bf16 v[20:23], v[30:33], v[136:139], v[20:23]
  v_mov_b32 v238, 158928
  s_mov_b32 s63, 800000
Lw_21:
  ds_read_b32 v239, v238
  s_waitcnt lgkmcnt(0)
  v_readfirstlane_b32 s99, v239
  s_nop 0
  s_cmp_ge_u32 s99, 1
  s_cbranch_scc1 Lwd_22
  s_sub_u32 s63, s63, 1
  s_cbranch_scc0 Lw_21
Lwd_22:
  ds_read_b128 v[242:245], v240
  s_waitcnt vmcnt(0)
  v_and_b32 v26, v84, v11
  v_and_b32 v27, v84, v14
  s_nop 1
  v_mfma_f32_16x16x32_bf16 v[16:19], v[26:29], v[140:143], v[16:19]
  v_mfma_f32_16x16x32_bf16 v[20:23], v[24:27], v[140:143], v[20:23]
  v_and_b32 v32, v85, v11
  v_and_b32 v33, v85, v14
  s_nop 1
  v_mfma_f32_16x16x32_bf16 v[16:19], v[32:35], v[144:147], v[16:19]
  v_mfma_f32_16x16x32_bf16 v[20:23], v[30:33], v[144:147], v[20:23]
  v_and_b32 v26, v86, v11
  v_and_b32 v27, v86, v14
  s_nop 1
  v_mfma_f32_16x16x32_bf16 v[16:19], v[26:29], v[148:151], v[16:19]
  v_mfma_f32_16x16x32_bf16 v[20:23], v[24:27], v[148:151], v[20:23]
  v_and_b32 v32, v87, v11
  v_and_b32 v33, v87, v14
  s_nop 1
  v_mfma_f32_16x16x32_bf16 v[16:19], v[32:35], v[152:155], v[16:19]
  v_mfma_f32_16x16x32_bf16 v[20:23], v[30:33], v[152:155], v[20:23]
  s_waitcnt lgkmcnt(0)
  s_nop 9
  v_mul_f32 v92, v242, v16
  v_mul_f32 v93, v242, v20
  v_mul_f32 v94, v243, v17
  v_mul_f32 v95, v243, v21
  v_mul_f32 v96, v244, v18
  v_mul_f32 v97, v244, v22
  v_mul_f32 v98, v245, v19
  v_mul_f32 v99, v245, v23
  ds_write_b64 v241, v[92:93] offset:0
  ds_write_b64 v241, v[94:95] offset:512
  ds_write_b64 v241, v[96:97] offset:1024
  ds_write_b64 v241, v[98:99] offset:1536
  s_waitcnt lgkmcnt(0)
  s_barrier
L_fin:
L_end:
  s_endpgm
.section .rodata,"a"
.p2align 6
.amdhsa_kernel sequential_preLN__gqa_block_cached__mixer_token_mlp__decode_kernel
  .amdhsa_next_free_vgpr 256
  .amdhsa_next_free_sgpr 102
  .amdhsa_accum_offset 256
  .amdhsa_group_segment_fixed_size 0
  .amdhsa_kernarg_size 104
  .amdhsa_user_sgpr_count 2
  .amdhsa_user_sgpr_kernarg_segment_ptr 1
  .amdhsa_system_sgpr_workgroup_id_x 1
  .amdhsa_float_denorm_mode_32 3
.end_amdhsa_kernel
```
